```python
import torch

def _softmax(x, axis=-1):
    return torch.softmax(x, dim=axis)
def _gelu(x):
    return torch.nn.functional.gelu(x, approximate="tanh")
def _silu(x):
    return torch.nn.functional.silu(x)
def _sigmoid(x):
    return torch.sigmoid(x)
def _layernorm(x, axis=-1, eps=1e-5):
    m = x.mean(dim=axis, keepdim=True)
    v = x.var(dim=axis, keepdim=True, unbiased=False)
    return (x - m) / torch.sqrt(v + eps)
def _scatter_add(tgt, idx, src, axis=0):
    return tgt.clone().index_add_(axis, idx, src)
def _segment_sum(src, seg, n):
    out = torch.zeros((n,) + src.shape[1:], dtype=src.dtype)
    return out.index_add_(0, seg, src)
def _pad(x, pw):
    flat = tuple(v for pair in reversed(pw) for v in pair)
    return torch.nn.functional.pad(x, flat)

kernel_name = 'gated_mix__sliding_block__sliding_block__prompt'

def setup_inputs():

    _w = (lambda a: (lambda t: t.to(torch.bfloat16) if t.is_floating_point() else t)(torch.as_tensor(a)))
    def _A_setup():
        B, S, D = 1, 2048, 512
        return {
            "x": _w((lambda *s: torch.randn(*s, dtype=torch.bfloat16) * 0.05)(B, S, D)),
            "wqkv": _w((lambda *s: torch.randn(*s, dtype=torch.bfloat16) * 1.6)(D, 3 * D)),
            "wo": _w((lambda *s: torch.randn(*s, dtype=torch.bfloat16) * 0.05)(D, D)),
        }
    _A_in = _A_setup()

    def _B_setup():
        B, S, D = 1, 2048, 512
        return {
            "x": _w((lambda *s: torch.randn(*s, dtype=torch.bfloat16) * 0.05)(B, S, D)),
            "wqkv": _w((lambda *s: torch.randn(*s, dtype=torch.bfloat16) * 1.6)(D, 3 * D)),
            "wo": _w((lambda *s: torch.randn(*s, dtype=torch.bfloat16) * 0.05)(D, D)),
        }
    _B_in = _B_setup()

    return {
        "A_x": _A_in["x"],
        "A_wqkv": _A_in["wqkv"],
        "A_wo": _A_in["wo"],
        "B_x": _B_in["x"],
        "B_wqkv": _B_in["wqkv"],
        "B_wo": _B_in["wo"],
        "gate_w": _w((lambda *s: torch.randn(*s, dtype=torch.bfloat16) * 0.05)(512) * 16.0),
    }

def reference(A_x, A_wqkv, A_wo, B_x, B_wqkv, B_wo, gate_w):
    def _A_ref(x, wqkv, wo):
        B, S, D = x.shape
        H = 32; Dh = D // H; W = 256
        qkv = (lambda x, *d: x.permute(*d))((x @ wqkv).reshape(B, S, 3, H, Dh), 2, 0, 3, 1, 4)
        q, k, v = qkv[0], qkv[1], qkv[2]
        scores = torch.einsum("bhqd,bhkd->bhqk", q, k) * (Dh ** -0.5)
        idx = torch.arange(S)
        mask = (idx[:, None] - idx[None, :] >= 0) & (idx[:, None] - idx[None, :] < W)
        scores = torch.where(mask[None, None], scores, -1e9)
        p = _softmax(scores, axis=-1)
        o = torch.einsum("bhqk,bhkd->bhqd", p, v)
        return (lambda x, *d: x.permute(*d))(o, 0, 2, 1, 3).reshape(B, S, D) @ wo

    def _B_ref(x, wqkv, wo):
        B, S, D = x.shape
        H = 32; Dh = D // H; W = 256
        qkv = (lambda x, *d: x.permute(*d))((x @ wqkv).reshape(B, S, 3, H, Dh), 2, 0, 3, 1, 4)
        q, k, v = qkv[0], qkv[1], qkv[2]
        scores = torch.einsum("bhqd,bhkd->bhqk", q, k) * (Dh ** -0.5)
        idx = torch.arange(S)
        mask = (idx[:, None] - idx[None, :] >= 0) & (idx[:, None] - idx[None, :] < W)
        scores = torch.where(mask[None, None], scores, -1e9)
        p = _softmax(scores, axis=-1)
        o = torch.einsum("bhqk,bhkd->bhqd", p, v)
        return (lambda x, *d: x.permute(*d))(o, 0, 2, 1, 3).reshape(B, S, D) @ wo

    x = A_x
    g = _sigmoid((x * gate_w).sum(-1, keepdims=True))
    a = _A_ref(x, A_wqkv, A_wo)
    b = _B_ref(x, B_wqkv, B_wo)
    return g * a + (1 - g) * b
```

```asm
; @launch grid=(256,1,1) block=(512,1,1) lds=163840
.amdgcn_target "amdgcn-amd-amdhsa--gfx950"
.text
.globl gated_mix__sliding_block__sliding_block__prompt_kernel
.p2align 8
.type gated_mix__sliding_block__sliding_block__prompt_kernel,@function
gated_mix__sliding_block__sliding_block__prompt_kernel:
  s_cmp_ge_u32 s2, 256
  s_cbranch_scc1 L_END
  s_getpc_b64 s[4:5]
L_PC:
  s_load_dwordx4 s[40:43], s[0:1], 0
  s_load_dwordx4 s[48:51], s[0:1], 32
  v_lshlrev_b32 v13, 6, v0
  s_load_dwordx2 s[44:45], s[0:1], 16
  s_load_dwordx4 s[52:55], s[0:1], 48
  s_load_dwordx4 s[56:59], s[0:1], 64
  v_min_u32 v13, L_CODE_END-L_PC-4, v13
  s_cmp_ge_u32 s2, 16
  s_cbranch_scc1 L_CPF_E
  v_lshlrev_b32 v13, 7, v0
  v_min_u32 v13, L_CODE_END-L_PC-4, v13
  global_load_dword v213, v13, s[4:5]
L_CPF_E:
  v_lshrrev_b32 v15, 6, v0
  v_and_b32 v0, 63, v0
  s_and_b32 s71, s2, 7
  v_readfirstlane_b32 s60, v15
  s_lshr_b32 s70, s2, 3
  s_and_b32 s72, s71, 1
  s_lshl_b32 s72, s72, 2
  s_and_b32 s73, s70, 3
  s_add_u32 s62, s72, s73
  s_lshr_b32 s72, s71, 1
  s_lshl_b32 s72, s72, 3
  s_lshr_b32 s68, s70, 2
  s_add_u32 s63, s72, s68
  s_lshr_b32 s64, s63, 4
  s_and_b32 s65, s63, 15
  s_lshl_b32 s67, s71, 2
  s_add_u32 s67, s67, s73
  s_sub_u32 s72, 11, s60
  s_cmp_lt_u32 s60, 4
  s_cselect_b32 s61, s60, s72
  s_lshl_b32 s66, s62, 3
  s_add_u32 s66, s66, s61
  v_lshlrev_b32 v12, 4, v0
  s_cmp_lt_u32 s60, 4
  s_cbranch_scc1 L_COMPUTE
L_LOADER:
  s_sub_u32 s76, s60, 4
  v_lshrrev_b32 v13, 2, v0
  v_mul_u32_u24 v13, 3072, v13
  v_and_b32 v15, 3, v0
  v_lshl_add_u32 v13, v15, 4, v13
  s_lshl_b32 s72, s65, 6
  v_add_u32 v9, s72, v13
  v_lshrrev_b32 v13, 3, v0
  v_lshlrev_b32 v13, 10, v13
  s_lshl_b32 s72, s62, 3
  s_lshl_b32 s73, s76, 1
  s_add_u32 s72, s72, s73
  s_lshl_b32 s72, s72, 15
  v_add_u32 v13, s72, v13
  v_lshrrev_b32 v15, 4, v0
  v_xor_b32 v15, v15, v0
  v_and_b32 v15, 7, v15
  v_lshl_add_u32 v1, v15, 4, v13
  v_xor_b32 v2, 64, v1
  v_add_u32 v3, 14336, v1
  v_add_u32 v4, 21504, v2
  v_add_u32 v2, 7168, v2
  s_and_b32 s72, s70, 3
  s_add_u32 s72, s72, s68
  s_and_b32 s71, s72, 3
  s_lshl_b32 s71, s71, 1
  s_waitcnt lgkmcnt(0)
  s_cmp_eq_u32 s64, 0
  s_cselect_b32 s12, s42, s48
  s_cselect_b32 s13, s43, s49
  s_mov_b32 s14, 1572864
  s_mov_b32 s15, 0x00020000
  s_mov_b32 s8, s40
  s_mov_b32 s9, s41
  s_mov_b32 s10, 2097152
  s_mov_b32 s11, 0x00020000
  s_mul_i32 s75, s76, 24576
  s_mul_i32 s83, s76, 49152
  s_lshl_b32 s40, s76, 10
  s_add_u32 s40, s40, 98304
  s_lshl_b32 s41, s71, 7
  s_mul_i32 s42, s41, 1536
  s_add_u32 s42, s42, s83
  s_add_u32 m0, s40, 0
  s_add_u32 s74, s42, 1024
  buffer_load_dwordx4 v9, s[12:15], s74 offen lds
  s_add_u32 m0, s40, 4096
  s_add_u32 s74, s42, 2048
  buffer_load_dwordx4 v9, s[12:15], s74 offen lds
  s_add_u32 m0, s40, 8192
  s_add_u32 s74, s42, 0
  buffer_load_dwordx4 v9, s[12:15], s74 offen lds
  s_add_u32 m0, s75, 0
  s_add_u32 s74, s41, 0
  buffer_load_dwordx4 v1, s[8:11], s74 offen offset:0 lds
  buffer_load_dwordx4 v2, s[8:11], s74 offen offset:1024 lds
  buffer_load_dwordx4 v3, s[8:11], s74 offen offset:2048 lds
  buffer_load_dwordx4 v4, s[8:11], s74 offen offset:3072 lds
  s_add_u32 m0, s75, 12288
  s_add_u32 s74, s41, 32768
  buffer_load_dwordx4 v1, s[8:11], s74 offen offset:0 lds
  buffer_load_dwordx4 v2, s[8:11], s74 offen offset:1024 lds
  buffer_load_dwordx4 v3, s[8:11], s74 offen offset:2048 lds
  buffer_load_dwordx4 v4, s[8:11], s74 offen offset:3072 lds
  s_add_u32 s41, s41, 128
  s_and_b32 s41, s41, 1023
  s_mul_i32 s42, s41, 1536
  s_add_u32 s42, s42, s83
  s_add_u32 m0, s40, 12288
  s_add_u32 s74, s42, 1024
  buffer_load_dwordx4 v9, s[12:15], s74 offen lds
  s_add_u32 m0, s40, 16384
  s_add_u32 s74, s42, 2048
  buffer_load_dwordx4 v9, s[12:15], s74 offen lds
  s_add_u32 m0, s40, 20480
  s_add_u32 s74, s42, 0
  buffer_load_dwordx4 v9, s[12:15], s74 offen lds
  s_add_u32 m0, s75, 4096
  s_add_u32 s74, s41, 0
  buffer_load_dwordx4 v1, s[8:11], s74 offen offset:0 lds
  buffer_load_dwordx4 v2, s[8:11], s74 offen offset:1024 lds
  buffer_load_dwordx4 v3, s[8:11], s74 offen offset:2048 lds
  buffer_load_dwordx4 v4, s[8:11], s74 offen offset:3072 lds
  s_add_u32 m0, s75, 16384
  s_add_u32 s74, s41, 32768
  buffer_load_dwordx4 v1, s[8:11], s74 offen offset:0 lds
  buffer_load_dwordx4 v2, s[8:11], s74 offen offset:1024 lds
  buffer_load_dwordx4 v3, s[8:11], s74 offen offset:2048 lds
  buffer_load_dwordx4 v4, s[8:11], s74 offen offset:3072 lds
  s_mov_b32 s24, s58
  s_mov_b32 s25, s59
  s_mov_b32 s26, 33554432
  s_mov_b32 s27, 0x00020000
  s_mov_b32 s36, s56
  s_mov_b32 s37, s57
  s_mov_b32 s38, 256
  s_mov_b32 s39, 0x00020000
  s_mov_b32 s28, s54
  s_mov_b32 s29, s55
  s_mov_b32 s30, 2097152
  s_mov_b32 s31, 0x00020000
  s_mov_b32 s32, s52
  s_mov_b32 s33, s53
  s_mov_b32 s34, 1024
  s_mov_b32 s35, 0x00020000
  s_mov_b32 s16, s44
  s_mov_b32 s17, s45
  s_mov_b32 s18, 524288
  s_mov_b32 s19, 0x00020000
  s_mov_b32 s20, s50
  s_mov_b32 s21, s51
  s_mov_b32 s22, 524288
  s_mov_b32 s23, 0x00020000
  s_mov_b32 s78, 0x0000ffff
  s_mov_b32 s79, 0x0000ffff
  s_mov_b32 s81, 0
  s_lshr_b32 s44, s60, 2
  s_and_b32 s45, s60, 3
  s_lshr_b32 s48, s45, 1
  s_and_b32 s49, s45, 1
  s_and_b32 s73, s67, 3
  s_sub_u32 s74, 7, s73
  s_cmp_eq_u32 s44, 0
  s_cselect_b32 s73, s73, s74
  s_lshr_b32 s50, s67, 2
  s_lshl_b32 s50, s50, 3
  s_add_u32 s50, s50, s73
  s_or_b32 s72, s2, s76
  s_cmp_lg_u32 s72, 0
  s_cbranch_scc1 L_NONCE_SKIP0
  v_mov_b32 v13, 0
  buffer_load_dword v14, v13, s[24:27], 0 offen sc1
L_NONCE_SKIP0:
  s_waitcnt vmcnt(11)
  s_barrier
  s_add_u32 s41, s41, 128
  s_and_b32 s41, s41, 1023
  s_mul_i32 s42, s41, 1536
  s_add_u32 s42, s42, s83
  s_add_u32 m0, s40, 24576
  s_add_u32 s74, s42, 1024
  buffer_load_dwordx4 v9, s[12:15], s74 offen lds
  s_add_u32 m0, s40, 28672
  s_add_u32 s74, s42, 2048
  buffer_load_dwordx4 v9, s[12:15], s74 offen lds
  s_add_u32 m0, s40, 32768
  s_add_u32 s74, s42, 0
  buffer_load_dwordx4 v9, s[12:15], s74 offen lds
  s_add_u32 m0, s75, 8192
  s_add_u32 s74, s41, 0
  buffer_load_dwordx4 v1, s[8:11], s74 offen offset:0 lds
  buffer_load_dwordx4 v2, s[8:11], s74 offen offset:1024 lds
  buffer_load_dwordx4 v3, s[8:11], s74 offen offset:2048 lds
  buffer_load_dwordx4 v4, s[8:11], s74 offen offset:3072 lds
  s_add_u32 m0, s75, 20480
  s_add_u32 s74, s41, 32768
  buffer_load_dwordx4 v1, s[8:11], s74 offen offset:0 lds
  buffer_load_dwordx4 v2, s[8:11], s74 offen offset:1024 lds
  buffer_load_dwordx4 v3, s[8:11], s74 offen offset:2048 lds
  buffer_load_dwordx4 v4, s[8:11], s74 offen offset:3072 lds
  s_cmp_eq_u32 s76, 0
  s_cbranch_scc0 L_TW1
  s_lshl_b32 s73, s63, 6
  s_lshl_b32 s74, s62, 3
  s_add_u32 s73, s73, s74
  s_lshl_b32 s73, s73, 12
  s_add_u32 s73, s73, 1048576
  v_mov_b32 v13, 65536
  v_writelane_b32 v13, s73, 1
  s_lshl_b32 s73, s62, 19
  s_add_u32 s73, s73, 16777216
  v_writelane_b32 v13, s73, 2
  s_lshr_b32 s73, s67, 2
  s_lshl_b32 s73, s73, 19
  s_add_u32 s73, s73, 16777216
  v_writelane_b32 v13, s73, 3
  s_mov_b64 exec, 15
  buffer_load_dword v215, v13, s[24:27], 0 offen sc1
  buffer_load_dword v214, v13, s[24:27], 0 offen offset:128 sc1
  s_mov_b64 exec, -1
  s_branch L_TWE
L_TW1:
  s_cmp_eq_u32 s76, 1
  s_cbranch_scc0 L_TW2
  s_lshr_b32 s73, s67, 2
  s_lshl_b32 s73, s73, 18
  v_mov_b32 v13, 0
  s_mov_b64 exec, 1
  buffer_load_dword v215, v13, s[28:31], s73 offen
  buffer_load_dword v214, v13, s[36:39], 0 offen sc1
  s_mov_b64 exec, -1
  s_branch L_TWE
L_TW2:
  s_cmp_eq_u32 s76, 2
  s_cbranch_scc0 L_TW3
  v_mov_b32 v13, 0
  s_mov_b64 exec, 1
  buffer_load_dword v215, v13, s[16:19], 0 offen
  buffer_load_dword v214, v13, s[20:23], 0 offen
  s_mov_b64 exec, -1
  s_branch L_TWE
L_TW3:
  v_mov_b32 v13, 0
  s_mov_b64 exec, 1
  buffer_load_dword v215, v13, s[32:35], 0 offen
  buffer_load_dword v214, v13, s[32:35], 0 offen offset:128
  s_mov_b64 exec, -1
L_TWE:
  s_branch L_F5_2
  s_cmp_eq_u32 s76, 0
  s_cbranch_scc0 L_F5_1
  s_lshl_b32 s73, s62, 5
  s_lshr_b32 s74, s63, 3
  s_add_u32 s73, s73, s74
  s_lshl_b32 s73, s73, 7
  s_add_u32 s73, s73, 65536
  v_and_b32 v13, 7, v0
  v_lshlrev_b32 v13, 9, v13
  s_mov_b64 exec, 0xff
  buffer_load_dword v215, v13, s[24:27], s73 offen sc1
  s_branch L_F5_E
L_F5_1:
  s_cmp_eq_u32 s76, 1
  s_cbranch_scc0 L_F5_2
  s_lshr_b32 s73, s67, 2
  s_lshl_b32 s73, s73, 3
  s_and_b32 s74, s67, 3
  s_add_u32 s71, s73, s74
  s_sub_u32 s74, 7, s74
  s_add_u32 s72, s73, s74
  s_lshl_b32 s71, s71, 9
  s_lshl_b32 s72, s72, 9
  s_sub_u32 s72, s72, s71
  s_sub_u32 s72, s72, 512
  s_add_u32 s71, s71, 65536
  v_and_b32 v13, 7, v0
  v_lshlrev_b32 v13, 7, v13
  v_bfe_u32 v15, v0, 2, 1
  v_mul_lo_u32 v15, v15, s72
  v_add_u32 v13, v13, v15
  s_mov_b64 exec, 0xff
  buffer_load_dword v215, v13, s[24:27], s71 offen sc1
  s_branch L_F5_E
L_F5_2:
  s_cmp_eq_u32 s76, 3
  s_cbranch_scc0 L_F5_3
  v_and_b32 v13, 7, v0
  v_lshlrev_b32 v13, 7, v13
  s_mov_b64 exec, 0xff
  buffer_load_dword v215, v13, s[32:35], 0 offen
  s_branch L_F5_E
L_F5_3:
  s_lshl_b32 s73, s62, 5
  s_add_u32 s73, s73, s63
  s_lshl_b32 s73, s73, 7
  s_add_u32 s73, s73, 12288
  v_and_b32 v13, 1, v0
  v_lshlrev_b32 v13, 12, v13
  s_mov_b64 exec, 3
  buffer_load_dword v215, v13, s[24:27], s73 offen sc1
L_F5_E:
  s_mov_b64 exec, -1
  s_or_b32 s72, s2, s76
  s_cmp_lg_u32 s72, 0
  s_cbranch_scc1 L_NONCE_SKIP1
  s_waitcnt vmcnt(11)
  v_readfirstlane_b32 s73, v14
  v_mov_b32 v13, 0
  s_nop 3
  s_add_u32 s73, s73, 1
  s_max_u32 s73, s73, 1
  v_mov_b32 v14, s73
  buffer_store_dword v14, v13, s[36:39], 0 offen sc1
  buffer_store_dword v14, v13, s[24:27], 0 offen sc1
L_NONCE_SKIP1:
  s_waitcnt vmcnt(14)
  s_barrier
  s_add_u32 s41, s41, 128
  s_and_b32 s41, s41, 1023
  s_mul_i32 s42, s41, 1536
  s_add_u32 s42, s42, s83
  s_add_u32 m0, s40, 0
  s_add_u32 s74, s42, 1024
  buffer_load_dwordx4 v9, s[12:15], s74 offen lds
  s_add_u32 m0, s40, 4096
  s_add_u32 s74, s42, 2048
  buffer_load_dwordx4 v9, s[12:15], s74 offen lds
  s_add_u32 m0, s40, 8192
  s_add_u32 s74, s42, 0
  buffer_load_dwordx4 v9, s[12:15], s74 offen lds
  s_add_u32 m0, s75, 0
  s_add_u32 s74, s41, 0
  buffer_load_dwordx4 v1, s[8:11], s74 offen offset:0 lds
  buffer_load_dwordx4 v2, s[8:11], s74 offen offset:1024 lds
  buffer_load_dwordx4 v3, s[8:11], s74 offen offset:2048 lds
  buffer_load_dwordx4 v4, s[8:11], s74 offen offset:3072 lds
  s_add_u32 m0, s75, 12288
  s_add_u32 s74, s41, 32768
  buffer_load_dwordx4 v1, s[8:11], s74 offen offset:0 lds
  buffer_load_dwordx4 v2, s[8:11], s74 offen offset:1024 lds
  buffer_load_dwordx4 v3, s[8:11], s74 offen offset:2048 lds
  buffer_load_dwordx4 v4, s[8:11], s74 offen offset:3072 lds
  s_waitcnt vmcnt(14)
  s_barrier
  s_add_u32 s41, s41, 128
  s_and_b32 s41, s41, 1023
  s_mul_i32 s42, s41, 1536
  s_add_u32 s42, s42, s83
  s_add_u32 m0, s40, 12288
  s_add_u32 s74, s42, 1024
  buffer_load_dwordx4 v9, s[12:15], s74 offen lds
  s_add_u32 m0, s40, 16384
  s_add_u32 s74, s42, 2048
  buffer_load_dwordx4 v9, s[12:15], s74 offen lds
  s_add_u32 m0, s40, 20480
  s_add_u32 s74, s42, 0
  buffer_load_dwordx4 v9, s[12:15], s74 offen lds
  s_add_u32 m0, s75, 4096
  s_add_u32 s74, s41, 0
  buffer_load_dwordx4 v1, s[8:11], s74 offen offset:0 lds
  buffer_load_dwordx4 v2, s[8:11], s74 offen offset:1024 lds
  buffer_load_dwordx4 v3, s[8:11], s74 offen offset:2048 lds
  buffer_load_dwordx4 v4, s[8:11], s74 offen offset:3072 lds
  s_add_u32 m0, s75, 16384
  s_add_u32 s74, s41, 32768
  buffer_load_dwordx4 v1, s[8:11], s74 offen offset:0 lds
  buffer_load_dwordx4 v2, s[8:11], s74 offen offset:1024 lds
  buffer_load_dwordx4 v3, s[8:11], s74 offen offset:2048 lds
  buffer_load_dwordx4 v4, s[8:11], s74 offen offset:3072 lds
  s_waitcnt vmcnt(11)
  s_barrier
  s_add_u32 s41, s41, 128
  s_and_b32 s41, s41, 1023
  s_mul_i32 s42, s41, 1536
  s_add_u32 s42, s42, s83
  s_add_u32 m0, s40, 24576
  s_add_u32 s74, s42, 1024
  buffer_load_dwordx4 v9, s[12:15], s74 offen lds
  s_add_u32 m0, s40, 28672
  s_add_u32 s74, s42, 2048
  buffer_load_dwordx4 v9, s[12:15], s74 offen lds
  s_add_u32 m0, s40, 32768
  s_add_u32 s74, s42, 0
  buffer_load_dwordx4 v9, s[12:15], s74 offen lds
  s_add_u32 m0, s75, 8192
  s_add_u32 s74, s41, 0
  buffer_load_dwordx4 v1, s[8:11], s74 offen offset:0 lds
  buffer_load_dwordx4 v2, s[8:11], s74 offen offset:1024 lds
  buffer_load_dwordx4 v3, s[8:11], s74 offen offset:2048 lds
  buffer_load_dwordx4 v4, s[8:11], s74 offen offset:3072 lds
  s_add_u32 m0, s75, 20480
  s_add_u32 s74, s41, 32768
  buffer_load_dwordx4 v1, s[8:11], s74 offen offset:0 lds
  buffer_load_dwordx4 v2, s[8:11], s74 offen offset:1024 lds
  buffer_load_dwordx4 v3, s[8:11], s74 offen offset:2048 lds
  buffer_load_dwordx4 v4, s[8:11], s74 offen offset:3072 lds
  s_waitcnt vmcnt(11)
  s_barrier
  s_add_u32 s41, s41, 128
  s_and_b32 s41, s41, 1023
  s_mul_i32 s42, s41, 1536
  s_add_u32 s42, s42, s83
  s_add_u32 m0, s40, 0
  s_add_u32 s74, s42, 1024
  buffer_load_dwordx4 v9, s[12:15], s74 offen lds
  s_add_u32 m0, s40, 4096
  s_add_u32 s74, s42, 2048
  buffer_load_dwordx4 v9, s[12:15], s74 offen lds
  s_add_u32 m0, s40, 8192
  s_add_u32 s74, s42, 0
  buffer_load_dwordx4 v9, s[12:15], s74 offen lds
  s_add_u32 m0, s75, 0
  s_add_u32 s74, s41, 0
  buffer_load_dwordx4 v1, s[8:11], s74 offen offset:0 lds
  buffer_load_dwordx4 v2, s[8:11], s74 offen offset:1024 lds
  buffer_load_dwordx4 v3, s[8:11], s74 offen offset:2048 lds
  buffer_load_dwordx4 v4, s[8:11], s74 offen offset:3072 lds
  s_add_u32 m0, s75, 12288
  s_add_u32 s74, s41, 32768
  buffer_load_dwordx4 v1, s[8:11], s74 offen offset:0 lds
  buffer_load_dwordx4 v2, s[8:11], s74 offen offset:1024 lds
  buffer_load_dwordx4 v3, s[8:11], s74 offen offset:2048 lds
  buffer_load_dwordx4 v4, s[8:11], s74 offen offset:3072 lds
  s_waitcnt vmcnt(11)
  s_barrier
  s_add_u32 s41, s41, 128
  s_and_b32 s41, s41, 1023
  s_mul_i32 s42, s41, 1536
  s_add_u32 s42, s42, s83
  s_add_u32 m0, s40, 12288
  s_add_u32 s74, s42, 1024
  buffer_load_dwordx4 v9, s[12:15], s74 offen lds
  s_add_u32 m0, s40, 16384
  s_add_u32 s74, s42, 2048
  buffer_load_dwordx4 v9, s[12:15], s74 offen lds
  s_add_u32 m0, s40, 20480
  s_add_u32 s74, s42, 0
  buffer_load_dwordx4 v9, s[12:15], s74 offen lds
  s_add_u32 m0, s75, 4096
  s_add_u32 s74, s41, 0
  buffer_load_dwordx4 v1, s[8:11], s74 offen offset:0 lds
  buffer_load_dwordx4 v2, s[8:11], s74 offen offset:1024 lds
  buffer_load_dwordx4 v3, s[8:11], s74 offen offset:2048 lds
  buffer_load_dwordx4 v4, s[8:11], s74 offen offset:3072 lds
  s_add_u32 m0, s75, 16384
  s_add_u32 s74, s41, 32768
  buffer_load_dwordx4 v1, s[8:11], s74 offen offset:0 lds
  buffer_load_dwordx4 v2, s[8:11], s74 offen offset:1024 lds
  buffer_load_dwordx4 v3, s[8:11], s74 offen offset:2048 lds
  buffer_load_dwordx4 v4, s[8:11], s74 offen offset:3072 lds
  s_and_b32 s73, s70, 15
  s_lshl_b32 s73, s73, 15
  s_lshl_b32 s74, s76, 13
  s_add_u32 s73, s73, s74
  v_lshlrev_b32 v15, 6, v0
  s_cmp_lt_u32 s70, 16
  s_cbranch_scc1 L_WOPF_A
  buffer_load_dword v213, v15, s[20:23], s73 offen
  s_add_u32 s73, s73, 4096
  buffer_load_dword v214, v15, s[20:23], s73 offen
  s_branch L_WOPF_E
L_WOPF_A:
  buffer_load_dword v213, v15, s[16:19], s73 offen
  s_add_u32 s73, s73, 4096
  buffer_load_dword v214, v15, s[16:19], s73 offen
L_WOPF_E:
  s_waitcnt vmcnt(13)
  s_barrier
  s_waitcnt vmcnt(2)
  s_barrier
  v_and_b32 v13, 31, v0
  v_lshrrev_b32 v15, 5, v0
  v_lshlrev_b32 v15, 2, v15
  v_sub_u32 v13, v13, v15
  v_subrev_u32 v16, 0, v13
  v_ashrrev_i32 v16, 31, v16
  v_and_b32 v16, 0xff800000, v16
  v_subrev_u32 v17, 1, v13
  v_ashrrev_i32 v17, 31, v17
  v_and_b32 v17, 0xff800000, v17
  v_subrev_u32 v18, 2, v13
  v_ashrrev_i32 v18, 31, v18
  v_and_b32 v18, 0xff800000, v18
  v_subrev_u32 v19, 3, v13
  v_ashrrev_i32 v19, 31, v19
  v_and_b32 v19, 0xff800000, v19
  v_subrev_u32 v20, 8, v13
  v_ashrrev_i32 v20, 31, v20
  v_and_b32 v20, 0xff800000, v20
  v_subrev_u32 v21, 9, v13
  v_ashrrev_i32 v21, 31, v21
  v_and_b32 v21, 0xff800000, v21
  v_subrev_u32 v22, 10, v13
  v_ashrrev_i32 v22, 31, v22
  v_and_b32 v22, 0xff800000, v22
  v_subrev_u32 v23, 11, v13
  v_ashrrev_i32 v23, 31, v23
  v_and_b32 v23, 0xff800000, v23
  v_subrev_u32 v24, 16, v13
  v_ashrrev_i32 v24, 31, v24
  v_and_b32 v24, 0xff800000, v24
  v_subrev_u32 v25, 17, v13
  v_ashrrev_i32 v25, 31, v25
  v_and_b32 v25, 0xff800000, v25
  v_subrev_u32 v26, 18, v13
  v_ashrrev_i32 v26, 31, v26
  v_and_b32 v26, 0xff800000, v26
  v_subrev_u32 v27, 19, v13
  v_ashrrev_i32 v27, 31, v27
  v_and_b32 v27, 0xff800000, v27
  v_subrev_u32 v28, 24, v13
  v_ashrrev_i32 v28, 31, v28
  v_and_b32 v28, 0xff800000, v28
  v_subrev_u32 v29, 25, v13
  v_ashrrev_i32 v29, 31, v29
  v_and_b32 v29, 0xff800000, v29
  v_subrev_u32 v30, 26, v13
  v_ashrrev_i32 v30, 31, v30
  v_and_b32 v30, 0xff800000, v30
  v_subrev_u32 v31, 27, v13
  v_ashrrev_i32 v31, 31, v31
  v_and_b32 v31, 0xff800000, v31
  v_mov_b32 v32, 0x3f803f80
  v_mov_b32 v33, 0x3f803f80
  v_mov_b32 v34, 0x3f803f80
  v_mov_b32 v35, 0x3f803f80
  v_mov_b32 v36, 0x3f803f80
  v_mov_b32 v37, 0x3f803f80
  v_mov_b32 v38, 0x3f803f80
  v_mov_b32 v39, 0x3f803f80
  v_mov_b32 v40, 0x3f803f80
  v_mov_b32 v41, 0x3f803f80
  v_mov_b32 v42, 0x3f803f80
  v_mov_b32 v43, 0x3f803f80
  v_mov_b32 v44, 0x3f803f80
  v_mov_b32 v45, 0x3f803f80
  v_mov_b32 v46, 0x3f803f80
  v_mov_b32 v47, 0x3f803f80
  v_mov_b32 v216, 0
  v_mov_b32 v217, 0
  v_mov_b32 v218, 0
  v_mov_b32 v219, 0
  v_mov_b32 v220, 0
  v_mov_b32 v221, 0
  v_mov_b32 v222, 0
  v_mov_b32 v223, 0
  v_mov_b32 v224, 0
  v_mov_b32 v225, 0
  v_mov_b32 v226, 0
  v_mov_b32 v227, 0
  v_mov_b32 v228, 0
  v_mov_b32 v229, 0
  v_mov_b32 v230, 0
  v_mov_b32 v231, 0
  v_mov_b32 v232, 0
  v_mov_b32 v233, 0
  v_mov_b32 v234, 0
  v_mov_b32 v235, 0
  v_mov_b32 v236, 0
  v_mov_b32 v237, 0
  v_mov_b32 v238, 0
  v_mov_b32 v239, 0
  v_mov_b32 v240, 0
  v_mov_b32 v241, 0
  v_mov_b32 v242, 0
  v_mov_b32 v243, 0
  v_mov_b32 v244, 0
  v_mov_b32 v245, 0
  v_mov_b32 v246, 0
  v_mov_b32 v247, 0
  s_mov_b32 s73, 0xff800000
  v_xor_b32 v144, s73, v16
  v_xor_b32 v145, s73, v17
  v_xor_b32 v146, s73, v18
  v_xor_b32 v147, s73, v19
  v_xor_b32 v148, s73, v20
  v_xor_b32 v149, s73, v21
  v_xor_b32 v150, s73, v22
  v_xor_b32 v151, s73, v23
  v_xor_b32 v152, s73, v24
  v_xor_b32 v153, s73, v25
  v_xor_b32 v154, s73, v26
  v_xor_b32 v155, s73, v27
  v_xor_b32 v156, s73, v28
  v_xor_b32 v157, s73, v29
  v_xor_b32 v158, s73, v30
  v_xor_b32 v159, s73, v31
  s_cmp_lg_u32 s76, 0
  s_cbranch_scc1 L_B1
  s_mov_b32 s80, 0
  v_mov_b32 v15, 0
  buffer_load_dword v14, v15, s[36:39], 0 offen sc1
L_TAG_LOOP:
  s_waitcnt vmcnt(0)
L_TAG_CHK:
  s_add_u32 s80, s80, 1
  v_readfirstlane_b32 s69, v14
  s_nop 3
  s_cmp_lg_u32 s69, 0
  s_cbranch_scc1 L_TAG_OK
  s_cmp_gt_u32 s80, 20000
  s_cbranch_scc1 L_TAG_OK
  buffer_load_dword v14, v15, s[36:39], 0 offen sc1
  s_branch L_TAG_LOOP
L_TAG_OK:
  v_mov_b32 v15, 10240
  ds_write_b32 v15, v14
  s_branch L_B1
L_COMPUTE:
  s_mul_i32 s75, s60, 24576
  v_and_b32 v13, 31, v0
  v_lshrrev_b32 v15, 5, v0
  v_bfe_u32 v6, v13, 1, 3
  v_xor_b32 v15, v15, v6
  v_lshlrev_b32 v15, 4, v15
  v_lshl_add_u32 v15, v13, 7, v15
  v_add_u32 v5, s75, v15
  v_xor_b32 v6, 32, v5
  v_xor_b32 v7, 64, v5
  v_xor_b32 v8, 96, v5
  v_lshrrev_b32 v13, 5, v0
  v_lshlrev_b32 v13, 9, v13
  v_bfe_u32 v15, v0, 2, 2
  v_lshl_add_u32 v13, v15, 6, v13
  v_bfe_u32 v15, v0, 4, 1
  v_lshl_add_u32 v13, v15, 5, v13
  v_and_b32 v15, 3, v0
  v_lshl_add_u32 v13, v15, 3, v13
  v_add_u32 v10, 98304, v13
  v_mov_b32 v216, 0
  v_mov_b32 v217, 0
  v_mov_b32 v218, 0
  v_mov_b32 v219, 0
  v_mov_b32 v220, 0
  v_mov_b32 v221, 0
  v_mov_b32 v222, 0
  v_mov_b32 v223, 0
  v_mov_b32 v224, 0
  v_mov_b32 v225, 0
  v_mov_b32 v226, 0
  v_mov_b32 v227, 0
  v_mov_b32 v228, 0
  v_mov_b32 v229, 0
  v_mov_b32 v230, 0
  v_mov_b32 v231, 0
  v_mov_b32 v232, 0
  v_mov_b32 v233, 0
  v_mov_b32 v234, 0
  v_mov_b32 v235, 0
  v_mov_b32 v236, 0
  v_mov_b32 v237, 0
  v_mov_b32 v238, 0
  v_mov_b32 v239, 0
  v_mov_b32 v240, 0
  v_mov_b32 v241, 0
  v_mov_b32 v242, 0
  v_mov_b32 v243, 0
  v_mov_b32 v244, 0
  v_mov_b32 v245, 0
  v_mov_b32 v246, 0
  v_mov_b32 v247, 0
  s_waitcnt lgkmcnt(0)
  s_mov_b32 s8, s40
  s_mov_b32 s9, s41
  s_mov_b32 s10, 2097152
  s_mov_b32 s11, 0x00020000
  s_cmp_eq_u32 s64, 0
  s_cselect_b32 s12, s42, s48
  s_cselect_b32 s13, s43, s49
  s_mov_b32 s14, 1572864
  s_mov_b32 s15, 0x00020000
  s_mov_b32 s24, s58
  s_mov_b32 s25, s59
  s_mov_b32 s26, 33554432
  s_mov_b32 s27, 0x00020000
  s_mov_b32 s36, s56
  s_mov_b32 s37, s57
  s_mov_b32 s38, 256
  s_mov_b32 s39, 0x00020000
  s_mov_b32 s28, s54
  s_mov_b32 s29, s55
  s_mov_b32 s30, 2097152
  s_mov_b32 s31, 0x00020000
  s_mov_b32 s32, s52
  s_mov_b32 s33, s53
  s_mov_b32 s34, 1024
  s_mov_b32 s35, 0x00020000
  s_mov_b32 s16, s44
  s_mov_b32 s17, s45
  s_mov_b32 s18, 524288
  s_mov_b32 s19, 0x00020000
  s_mov_b32 s20, s50
  s_mov_b32 s21, s51
  s_mov_b32 s22, 524288
  s_mov_b32 s23, 0x00020000
  s_mov_b32 s78, 0x0000ffff
  s_mov_b32 s79, 0x0000ffff
  s_mov_b32 s81, 0
  s_lshr_b32 s44, s60, 2
  s_and_b32 s45, s60, 3
  s_lshr_b32 s48, s45, 1
  s_and_b32 s49, s45, 1
  s_and_b32 s73, s67, 3
  s_sub_u32 s74, 7, s73
  s_cmp_eq_u32 s44, 0
  s_cselect_b32 s73, s73, s74
  s_lshr_b32 s50, s67, 2
  s_lshl_b32 s50, s50, 3
  s_add_u32 s50, s50, s73
  s_barrier
  ds_read_b64_tr_b16 v[80:81], v10 offset:0
  ds_read_b64_tr_b16 v[82:83], v10 offset:256
  ds_read_b64_tr_b16 v[84:85], v10 offset:4096
  ds_read_b64_tr_b16 v[86:87], v10 offset:4352
  ds_read_b64_tr_b16 v[88:89], v10 offset:8192
  ds_read_b64_tr_b16 v[90:91], v10 offset:8448
  ds_read_b128 v[16:19], v5 offset:0
  ds_read_b128 v[32:35], v5 offset:12288
  ds_read_b64_tr_b16 v[92:93], v10 offset:1024
  ds_read_b64_tr_b16 v[94:95], v10 offset:1280
  ds_read_b64_tr_b16 v[96:97], v10 offset:5120
  ds_read_b64_tr_b16 v[98:99], v10 offset:5376
  ds_read_b64_tr_b16 v[100:101], v10 offset:9216
  ds_read_b64_tr_b16 v[102:103], v10 offset:9472
  ds_read_b128 v[20:23], v6 offset:0
  ds_read_b128 v[36:39], v6 offset:12288
  ds_read_b128 v[24:27], v7 offset:0
  ds_read_b128 v[40:43], v7 offset:12288
  ds_read_b128 v[28:31], v8 offset:0
  ds_read_b128 v[44:47], v8 offset:12288
  s_waitcnt lgkmcnt(14)
  s_waitcnt lgkmcnt(12)
  v_mfma_f32_32x32x16_bf16 v[132:147], v[80:83], v[16:19], 0
  ds_read_b64_tr_b16 v[104:105], v10 offset:2048
  ds_read_b64_tr_b16 v[106:107], v10 offset:2304
  v_mfma_f32_32x32x16_bf16 v[180:195], v[80:83], v[32:35], 0
  ds_read_b64_tr_b16 v[108:109], v10 offset:6144
  ds_read_b64_tr_b16 v[110:111], v10 offset:6400
  v_mfma_f32_32x32x16_bf16 v[148:163], v[16:19], v[84:87], 0
  ds_read_b64_tr_b16 v[112:113], v10 offset:10240
  ds_read_b64_tr_b16 v[114:115], v10 offset:10496
  v_mfma_f32_32x32x16_bf16 v[196:211], v[32:35], v[84:87], 0
  v_mfma_f32_32x32x16_bf16 v[116:131], v[88:91], v[16:19], 0
  v_mfma_f32_32x32x16_bf16 v[164:179], v[88:91], v[32:35], 0
  s_waitcnt lgkmcnt(12)
  s_waitcnt lgkmcnt(10)
  v_mfma_f32_32x32x16_bf16 v[132:147], v[92:95], v[20:23], v[132:147]
  ds_read_b64_tr_b16 v[80:81], v10 offset:3072
  ds_read_b64_tr_b16 v[82:83], v10 offset:3328
  v_mfma_f32_32x32x16_bf16 v[180:195], v[92:95], v[36:39], v[180:195]
  ds_read_b64_tr_b16 v[84:85], v10 offset:7168
  ds_read_b64_tr_b16 v[86:87], v10 offset:7424
  v_mfma_f32_32x32x16_bf16 v[148:163], v[20:23], v[96:99], v[148:163]
  ds_read_b64_tr_b16 v[88:89], v10 offset:11264
  ds_read_b64_tr_b16 v[90:91], v10 offset:11520
  v_mfma_f32_32x32x16_bf16 v[196:211], v[36:39], v[96:99], v[196:211]
  v_mfma_f32_32x32x16_bf16 v[116:131], v[100:103], v[20:23], v[116:131]
  v_mfma_f32_32x32x16_bf16 v[164:179], v[100:103], v[36:39], v[164:179]
  s_waitcnt lgkmcnt(0)
  s_barrier
  v_mfma_f32_32x32x16_bf16 v[132:147], v[104:107], v[24:27], v[132:147]
  ds_read_b64_tr_b16 v[92:93], v10 offset:12288
  ds_read_b64_tr_b16 v[94:95], v10 offset:12544
  v_mfma_f32_32x32x16_bf16 v[180:195], v[104:107], v[40:43], v[180:195]
  ds_read_b64_tr_b16 v[96:97], v10 offset:16384
  ds_read_b64_tr_b16 v[98:99], v10 offset:16640
  v_mfma_f32_32x32x16_bf16 v[148:163], v[24:27], v[108:111], v[148:163]
  ds_read_b64_tr_b16 v[100:101], v10 offset:20480
  ds_read_b64_tr_b16 v[102:103], v10 offset:20736
  v_mfma_f32_32x32x16_bf16 v[196:211], v[40:43], v[108:111], v[196:211]
  ds_read_b128 v[48:51], v5 offset:4096
  ds_read_b128 v[64:67], v5 offset:16384
  v_mfma_f32_32x32x16_bf16 v[116:131], v[112:115], v[24:27], v[116:131]
  ds_read_b128 v[52:55], v6 offset:4096
  ds_read_b128 v[68:71], v6 offset:16384
  v_mfma_f32_32x32x16_bf16 v[164:179], v[112:115], v[40:43], v[164:179]
  v_mfma_f32_32x32x16_bf16 v[132:147], v[80:83], v[28:31], v[132:147]
  ds_read_b64_tr_b16 v[104:105], v10 offset:13312
  ds_read_b64_tr_b16 v[106:107], v10 offset:13568
  v_mfma_f32_32x32x16_bf16 v[180:195], v[80:83], v[44:47], v[180:195]
  ds_read_b64_tr_b16 v[108:109], v10 offset:17408
  ds_read_b64_tr_b16 v[110:111], v10 offset:17664
  v_mfma_f32_32x32x16_bf16 v[148:163], v[28:31], v[84:87], v[148:163]
  ds_read_b64_tr_b16 v[112:113], v10 offset:21504
  ds_read_b64_tr_b16 v[114:115], v10 offset:21760
  v_mfma_f32_32x32x16_bf16 v[196:211], v[44:47], v[84:87], v[196:211]
  ds_read_b128 v[56:59], v7 offset:4096
  ds_read_b128 v[72:75], v7 offset:16384
  v_mfma_f32_32x32x16_bf16 v[116:131], v[88:91], v[28:31], v[116:131]
  ds_read_b128 v[60:63], v8 offset:4096
  ds_read_b128 v[76:79], v8 offset:16384
  v_mfma_f32_32x32x16_bf16 v[164:179], v[88:91], v[44:47], v[164:179]
  s_waitcnt lgkmcnt(14)
  s_waitcnt lgkmcnt(12)
  v_mfma_f32_32x32x16_bf16 v[132:147], v[92:95], v[48:51], v[132:147]
  ds_read_b64_tr_b16 v[80:81], v10 offset:14336
  ds_read_b64_tr_b16 v[82:83], v10 offset:14592
  v_mfma_f32_32x32x16_bf16 v[180:195], v[92:95], v[64:67], v[180:195]
  ds_read_b64_tr_b16 v[84:85], v10 offset:18432
  ds_read_b64_tr_b16 v[86:87], v10 offset:18688
  v_mfma_f32_32x32x16_bf16 v[148:163], v[48:51], v[96:99], v[148:163]
  ds_read_b64_tr_b16 v[88:89], v10 offset:22528
  ds_read_b64_tr_b16 v[90:91], v10 offset:22784
  v_mfma_f32_32x32x16_bf16 v[196:211], v[64:67], v[96:99], v[196:211]
  v_mfma_f32_32x32x16_bf16 v[116:131], v[100:103], v[48:51], v[116:131]
  v_mfma_f32_32x32x16_bf16 v[164:179], v[100:103], v[64:67], v[164:179]
  s_waitcnt lgkmcnt(10)
  v_mfma_f32_32x32x16_bf16 v[132:147], v[104:107], v[52:55], v[132:147]
  ds_read_b64_tr_b16 v[92:93], v10 offset:15360
  ds_read_b64_tr_b16 v[94:95], v10 offset:15616
  v_mfma_f32_32x32x16_bf16 v[180:195], v[104:107], v[68:71], v[180:195]
  ds_read_b64_tr_b16 v[96:97], v10 offset:19456
  ds_read_b64_tr_b16 v[98:99], v10 offset:19712
  v_mfma_f32_32x32x16_bf16 v[148:163], v[52:55], v[108:111], v[148:163]
  ds_read_b64_tr_b16 v[100:101], v10 offset:23552
  ds_read_b64_tr_b16 v[102:103], v10 offset:23808
  v_mfma_f32_32x32x16_bf16 v[196:211], v[68:71], v[108:111], v[196:211]
  v_mfma_f32_32x32x16_bf16 v[116:131], v[112:115], v[52:55], v[116:131]
  v_mfma_f32_32x32x16_bf16 v[164:179], v[112:115], v[68:71], v[164:179]
  s_waitcnt lgkmcnt(0)
  s_barrier
  v_mfma_f32_32x32x16_bf16 v[132:147], v[80:83], v[56:59], v[132:147]
  ds_read_b64_tr_b16 v[104:105], v10 offset:24576
  ds_read_b64_tr_b16 v[106:107], v10 offset:24832
  v_mfma_f32_32x32x16_bf16 v[180:195], v[80:83], v[72:75], v[180:195]
  ds_read_b64_tr_b16 v[108:109], v10 offset:28672
  ds_read_b64_tr_b16 v[110:111], v10 offset:28928
  v_mfma_f32_32x32x16_bf16 v[148:163], v[56:59], v[84:87], v[148:163]
  ds_read_b64_tr_b16 v[112:113], v10 offset:32768
  ds_read_b64_tr_b16 v[114:115], v10 offset:33024
  v_mfma_f32_32x32x16_bf16 v[196:211], v[72:75], v[84:87], v[196:211]
  ds_read_b128 v[16:19], v5 offset:8192
  ds_read_b128 v[32:35], v5 offset:20480
  v_mfma_f32_32x32x16_bf16 v[116:131], v[88:91], v[56:59], v[116:131]
  ds_read_b128 v[20:23], v6 offset:8192
  ds_read_b128 v[36:39], v6 offset:20480
  v_mfma_f32_32x32x16_bf16 v[164:179], v[88:91], v[72:75], v[164:179]
  v_mfma_f32_32x32x16_bf16 v[132:147], v[92:95], v[60:63], v[132:147]
  ds_read_b64_tr_b16 v[80:81], v10 offset:25600
  ds_read_b64_tr_b16 v[82:83], v10 offset:25856
  v_mfma_f32_32x32x16_bf16 v[180:195], v[92:95], v[76:79], v[180:195]
  ds_read_b64_tr_b16 v[84:85], v10 offset:29696
  ds_read_b64_tr_b16 v[86:87], v10 offset:29952
  v_mfma_f32_32x32x16_bf16 v[148:163], v[60:63], v[96:99], v[148:163]
  ds_read_b64_tr_b16 v[88:89], v10 offset:33792
  ds_read_b64_tr_b16 v[90:91], v10 offset:34048
  v_mfma_f32_32x32x16_bf16 v[196:211], v[76:79], v[96:99], v[196:211]
  ds_read_b128 v[24:27], v7 offset:8192
  ds_read_b128 v[40:43], v7 offset:20480
  v_mfma_f32_32x32x16_bf16 v[116:131], v[100:103], v[60:63], v[116:131]
  ds_read_b128 v[28:31], v8 offset:8192
  ds_read_b128 v[44:47], v8 offset:20480
  v_mfma_f32_32x32x16_bf16 v[164:179], v[100:103], v[76:79], v[164:179]
  s_waitcnt lgkmcnt(14)
  s_waitcnt lgkmcnt(12)
  v_mfma_f32_32x32x16_bf16 v[132:147], v[104:107], v[16:19], v[132:147]
  ds_read_b64_tr_b16 v[92:93], v10 offset:26624
  ds_read_b64_tr_b16 v[94:95], v10 offset:26880
  v_mfma_f32_32x32x16_bf16 v[180:195], v[104:107], v[32:35], v[180:195]
  ds_read_b64_tr_b16 v[96:97], v10 offset:30720
  ds_read_b64_tr_b16 v[98:99], v10 offset:30976
  v_mfma_f32_32x32x16_bf16 v[148:163], v[16:19], v[108:111], v[148:163]
  ds_read_b64_tr_b16 v[100:101], v10 offset:34816
  ds_read_b64_tr_b16 v[102:103], v10 offset:35072
  v_mfma_f32_32x32x16_bf16 v[196:211], v[32:35], v[108:111], v[196:211]
  v_mfma_f32_32x32x16_bf16 v[116:131], v[112:115], v[16:19], v[116:131]
  v_mfma_f32_32x32x16_bf16 v[164:179], v[112:115], v[32:35], v[164:179]
  s_waitcnt lgkmcnt(10)
  v_mfma_f32_32x32x16_bf16 v[132:147], v[80:83], v[20:23], v[132:147]
  ds_read_b64_tr_b16 v[104:105], v10 offset:27648
  ds_read_b64_tr_b16 v[106:107], v10 offset:27904
  v_mfma_f32_32x32x16_bf16 v[180:195], v[80:83], v[36:39], v[180:195]
  ds_read_b64_tr_b16 v[108:109], v10 offset:31744
  ds_read_b64_tr_b16 v[110:111], v10 offset:32000
  v_mfma_f32_32x32x16_bf16 v[148:163], v[20:23], v[84:87], v[148:163]
  ds_read_b64_tr_b16 v[112:113], v10 offset:35840
  ds_read_b64_tr_b16 v[114:115], v10 offset:36096
  v_mfma_f32_32x32x16_bf16 v[196:211], v[36:39], v[84:87], v[196:211]
  v_mfma_f32_32x32x16_bf16 v[116:131], v[88:91], v[20:23], v[116:131]
  v_mfma_f32_32x32x16_bf16 v[164:179], v[88:91], v[36:39], v[164:179]
  s_waitcnt lgkmcnt(0)
  s_barrier
  v_mfma_f32_32x32x16_bf16 v[132:147], v[92:95], v[24:27], v[132:147]
  ds_read_b64_tr_b16 v[80:81], v10 offset:0
  ds_read_b64_tr_b16 v[82:83], v10 offset:256
  v_mfma_f32_32x32x16_bf16 v[180:195], v[92:95], v[40:43], v[180:195]
  ds_read_b64_tr_b16 v[84:85], v10 offset:4096
  ds_read_b64_tr_b16 v[86:87], v10 offset:4352
  v_mfma_f32_32x32x16_bf16 v[148:163], v[24:27], v[96:99], v[148:163]
  ds_read_b64_tr_b16 v[88:89], v10 offset:8192
  ds_read_b64_tr_b16 v[90:91], v10 offset:8448
  v_mfma_f32_32x32x16_bf16 v[196:211], v[40:43], v[96:99], v[196:211]
  ds_read_b128 v[48:51], v5 offset:0
  ds_read_b128 v[64:67], v5 offset:12288
  v_mfma_f32_32x32x16_bf16 v[116:131], v[100:103], v[24:27], v[116:131]
  ds_read_b128 v[52:55], v6 offset:0
  ds_read_b128 v[68:71], v6 offset:12288
  v_mfma_f32_32x32x16_bf16 v[164:179], v[100:103], v[40:43], v[164:179]
  v_mfma_f32_32x32x16_bf16 v[132:147], v[104:107], v[28:31], v[132:147]
  ds_read_b64_tr_b16 v[92:93], v10 offset:1024
  ds_read_b64_tr_b16 v[94:95], v10 offset:1280
  v_mfma_f32_32x32x16_bf16 v[180:195], v[104:107], v[44:47], v[180:195]
  ds_read_b64_tr_b16 v[96:97], v10 offset:5120
  ds_read_b64_tr_b16 v[98:99], v10 offset:5376
  v_mfma_f32_32x32x16_bf16 v[148:163], v[28:31], v[108:111], v[148:163]
  ds_read_b64_tr_b16 v[100:101], v10 offset:9216
  ds_read_b64_tr_b16 v[102:103], v10 offset:9472
  v_mfma_f32_32x32x16_bf16 v[196:211], v[44:47], v[108:111], v[196:211]
  ds_read_b128 v[56:59], v7 offset:0
  ds_read_b128 v[72:75], v7 offset:12288
  v_mfma_f32_32x32x16_bf16 v[116:131], v[112:115], v[28:31], v[116:131]
  ds_read_b128 v[60:63], v8 offset:0
  ds_read_b128 v[76:79], v8 offset:12288
  v_mfma_f32_32x32x16_bf16 v[164:179], v[112:115], v[44:47], v[164:179]
  s_waitcnt lgkmcnt(14)
  s_waitcnt lgkmcnt(12)
  v_mfma_f32_32x32x16_bf16 v[132:147], v[80:83], v[48:51], v[132:147]
  ds_read_b64_tr_b16 v[104:105], v10 offset:2048
  ds_read_b64_tr_b16 v[106:107], v10 offset:2304
  v_mfma_f32_32x32x16_bf16 v[180:195], v[80:83], v[64:67], v[180:195]
  ds_read_b64_tr_b16 v[108:109], v10 offset:6144
  ds_read_b64_tr_b16 v[110:111], v10 offset:6400
  v_mfma_f32_32x32x16_bf16 v[148:163], v[48:51], v[84:87], v[148:163]
  ds_read_b64_tr_b16 v[112:113], v10 offset:10240
  ds_read_b64_tr_b16 v[114:115], v10 offset:10496
  v_mfma_f32_32x32x16_bf16 v[196:211], v[64:67], v[84:87], v[196:211]
  v_mfma_f32_32x32x16_bf16 v[116:131], v[88:91], v[48:51], v[116:131]
  v_mfma_f32_32x32x16_bf16 v[164:179], v[88:91], v[64:67], v[164:179]
  s_waitcnt lgkmcnt(10)
  v_mfma_f32_32x32x16_bf16 v[132:147], v[92:95], v[52:55], v[132:147]
  ds_read_b64_tr_b16 v[80:81], v10 offset:3072
  ds_read_b64_tr_b16 v[82:83], v10 offset:3328
  v_mfma_f32_32x32x16_bf16 v[180:195], v[92:95], v[68:71], v[180:195]
  ds_read_b64_tr_b16 v[84:85], v10 offset:7168
  ds_read_b64_tr_b16 v[86:87], v10 offset:7424
  v_mfma_f32_32x32x16_bf16 v[148:163], v[52:55], v[96:99], v[148:163]
  ds_read_b64_tr_b16 v[88:89], v10 offset:11264
  ds_read_b64_tr_b16 v[90:91], v10 offset:11520
  v_mfma_f32_32x32x16_bf16 v[196:211], v[68:71], v[96:99], v[196:211]
  v_mfma_f32_32x32x16_bf16 v[116:131], v[100:103], v[52:55], v[116:131]
  v_mfma_f32_32x32x16_bf16 v[164:179], v[100:103], v[68:71], v[164:179]
  s_waitcnt lgkmcnt(0)
  s_barrier
  v_mfma_f32_32x32x16_bf16 v[132:147], v[104:107], v[56:59], v[132:147]
  ds_read_b64_tr_b16 v[92:93], v10 offset:12288
  ds_read_b64_tr_b16 v[94:95], v10 offset:12544
  v_mfma_f32_32x32x16_bf16 v[180:195], v[104:107], v[72:75], v[180:195]
  ds_read_b64_tr_b16 v[96:97], v10 offset:16384
  ds_read_b64_tr_b16 v[98:99], v10 offset:16640
  v_mfma_f32_32x32x16_bf16 v[148:163], v[56:59], v[108:111], v[148:163]
  ds_read_b64_tr_b16 v[100:101], v10 offset:20480
  ds_read_b64_tr_b16 v[102:103], v10 offset:20736
  v_mfma_f32_32x32x16_bf16 v[196:211], v[72:75], v[108:111], v[196:211]
  ds_read_b128 v[16:19], v5 offset:4096
  ds_read_b128 v[32:35], v5 offset:16384
  v_mfma_f32_32x32x16_bf16 v[116:131], v[112:115], v[56:59], v[116:131]
  ds_read_b128 v[20:23], v6 offset:4096
  ds_read_b128 v[36:39], v6 offset:16384
  v_mfma_f32_32x32x16_bf16 v[164:179], v[112:115], v[72:75], v[164:179]
  v_mfma_f32_32x32x16_bf16 v[132:147], v[80:83], v[60:63], v[132:147]
  ds_read_b64_tr_b16 v[104:105], v10 offset:13312
  ds_read_b64_tr_b16 v[106:107], v10 offset:13568
  v_mfma_f32_32x32x16_bf16 v[180:195], v[80:83], v[76:79], v[180:195]
  ds_read_b64_tr_b16 v[108:109], v10 offset:17408
  ds_read_b64_tr_b16 v[110:111], v10 offset:17664
  v_mfma_f32_32x32x16_bf16 v[148:163], v[60:63], v[84:87], v[148:163]
  ds_read_b64_tr_b16 v[112:113], v10 offset:21504
  ds_read_b64_tr_b16 v[114:115], v10 offset:21760
  v_mfma_f32_32x32x16_bf16 v[196:211], v[76:79], v[84:87], v[196:211]
  ds_read_b128 v[24:27], v7 offset:4096
  ds_read_b128 v[40:43], v7 offset:16384
  v_mfma_f32_32x32x16_bf16 v[116:131], v[88:91], v[60:63], v[116:131]
  ds_read_b128 v[28:31], v8 offset:4096
  ds_read_b128 v[44:47], v8 offset:16384
  v_mfma_f32_32x32x16_bf16 v[164:179], v[88:91], v[76:79], v[164:179]
  s_waitcnt lgkmcnt(14)
  s_waitcnt lgkmcnt(12)
  v_mfma_f32_32x32x16_bf16 v[132:147], v[92:95], v[16:19], v[132:147]
  ds_read_b64_tr_b16 v[80:81], v10 offset:14336
  ds_read_b64_tr_b16 v[82:83], v10 offset:14592
  v_mfma_f32_32x32x16_bf16 v[180:195], v[92:95], v[32:35], v[180:195]
  ds_read_b64_tr_b16 v[84:85], v10 offset:18432
  ds_read_b64_tr_b16 v[86:87], v10 offset:18688
  v_mfma_f32_32x32x16_bf16 v[148:163], v[16:19], v[96:99], v[148:163]
  ds_read_b64_tr_b16 v[88:89], v10 offset:22528
  ds_read_b64_tr_b16 v[90:91], v10 offset:22784
  v_mfma_f32_32x32x16_bf16 v[196:211], v[32:35], v[96:99], v[196:211]
  v_mfma_f32_32x32x16_bf16 v[116:131], v[100:103], v[16:19], v[116:131]
  v_mfma_f32_32x32x16_bf16 v[164:179], v[100:103], v[32:35], v[164:179]
  s_waitcnt lgkmcnt(10)
  v_mfma_f32_32x32x16_bf16 v[132:147], v[104:107], v[20:23], v[132:147]
  ds_read_b64_tr_b16 v[92:93], v10 offset:15360
  ds_read_b64_tr_b16 v[94:95], v10 offset:15616
  v_mfma_f32_32x32x16_bf16 v[180:195], v[104:107], v[36:39], v[180:195]
  ds_read_b64_tr_b16 v[96:97], v10 offset:19456
  ds_read_b64_tr_b16 v[98:99], v10 offset:19712
  v_mfma_f32_32x32x16_bf16 v[148:163], v[20:23], v[108:111], v[148:163]
  ds_read_b64_tr_b16 v[100:101], v10 offset:23552
  ds_read_b64_tr_b16 v[102:103], v10 offset:23808
  v_mfma_f32_32x32x16_bf16 v[196:211], v[36:39], v[108:111], v[196:211]
  v_mfma_f32_32x32x16_bf16 v[116:131], v[112:115], v[20:23], v[116:131]
  v_mfma_f32_32x32x16_bf16 v[164:179], v[112:115], v[36:39], v[164:179]
  s_waitcnt lgkmcnt(0)
  s_barrier
  v_mfma_f32_32x32x16_bf16 v[132:147], v[80:83], v[24:27], v[132:147]
  ds_read_b64_tr_b16 v[104:105], v10 offset:24576
  ds_read_b64_tr_b16 v[106:107], v10 offset:24832
  v_mfma_f32_32x32x16_bf16 v[180:195], v[80:83], v[40:43], v[180:195]
  ds_read_b64_tr_b16 v[108:109], v10 offset:28672
  ds_read_b64_tr_b16 v[110:111], v10 offset:28928
  v_mfma_f32_32x32x16_bf16 v[148:163], v[24:27], v[84:87], v[148:163]
  ds_read_b64_tr_b16 v[112:113], v10 offset:32768
  ds_read_b64_tr_b16 v[114:115], v10 offset:33024
  v_mfma_f32_32x32x16_bf16 v[196:211], v[40:43], v[84:87], v[196:211]
  ds_read_b128 v[48:51], v5 offset:8192
  ds_read_b128 v[64:67], v5 offset:20480
  v_mfma_f32_32x32x16_bf16 v[116:131], v[88:91], v[24:27], v[116:131]
  ds_read_b128 v[52:55], v6 offset:8192
  ds_read_b128 v[68:71], v6 offset:20480
  v_mfma_f32_32x32x16_bf16 v[164:179], v[88:91], v[40:43], v[164:179]
  v_mfma_f32_32x32x16_bf16 v[132:147], v[92:95], v[28:31], v[132:147]
  ds_read_b64_tr_b16 v[80:81], v10 offset:25600
  ds_read_b64_tr_b16 v[82:83], v10 offset:25856
  v_mfma_f32_32x32x16_bf16 v[180:195], v[92:95], v[44:47], v[180:195]
  ds_read_b64_tr_b16 v[84:85], v10 offset:29696
  ds_read_b64_tr_b16 v[86:87], v10 offset:29952
  v_mfma_f32_32x32x16_bf16 v[148:163], v[28:31], v[96:99], v[148:163]
  ds_read_b64_tr_b16 v[88:89], v10 offset:33792
  ds_read_b64_tr_b16 v[90:91], v10 offset:34048
  v_mfma_f32_32x32x16_bf16 v[196:211], v[44:47], v[96:99], v[196:211]
  ds_read_b128 v[56:59], v7 offset:8192
  ds_read_b128 v[72:75], v7 offset:20480
  v_mfma_f32_32x32x16_bf16 v[116:131], v[100:103], v[28:31], v[116:131]
  ds_read_b128 v[60:63], v8 offset:8192
  ds_read_b128 v[76:79], v8 offset:20480
  v_mfma_f32_32x32x16_bf16 v[164:179], v[100:103], v[44:47], v[164:179]
  s_waitcnt lgkmcnt(14)
  s_waitcnt lgkmcnt(12)
  v_mfma_f32_32x32x16_bf16 v[132:147], v[104:107], v[48:51], v[132:147]
  ds_read_b64_tr_b16 v[92:93], v10 offset:26624
  ds_read_b64_tr_b16 v[94:95], v10 offset:26880
  v_mfma_f32_32x32x16_bf16 v[180:195], v[104:107], v[64:67], v[180:195]
  ds_read_b64_tr_b16 v[96:97], v10 offset:30720
  ds_read_b64_tr_b16 v[98:99], v10 offset:30976
  v_mfma_f32_32x32x16_bf16 v[148:163], v[48:51], v[108:111], v[148:163]
  ds_read_b64_tr_b16 v[100:101], v10 offset:34816
  ds_read_b64_tr_b16 v[102:103], v10 offset:35072
  v_mfma_f32_32x32x16_bf16 v[196:211], v[64:67], v[108:111], v[196:211]
  v_mfma_f32_32x32x16_bf16 v[116:131], v[112:115], v[48:51], v[116:131]
  v_mfma_f32_32x32x16_bf16 v[164:179], v[112:115], v[64:67], v[164:179]
  s_waitcnt lgkmcnt(10)
  v_mfma_f32_32x32x16_bf16 v[132:147], v[80:83], v[52:55], v[132:147]
  ds_read_b64_tr_b16 v[104:105], v10 offset:27648
  ds_read_b64_tr_b16 v[106:107], v10 offset:27904
  v_mfma_f32_32x32x16_bf16 v[180:195], v[80:83], v[68:71], v[180:195]
  ds_read_b64_tr_b16 v[108:109], v10 offset:31744
  ds_read_b64_tr_b16 v[110:111], v10 offset:32000
  v_mfma_f32_32x32x16_bf16 v[148:163], v[52:55], v[84:87], v[148:163]
  ds_read_b64_tr_b16 v[112:113], v10 offset:35840
  ds_read_b64_tr_b16 v[114:115], v10 offset:36096
  v_mfma_f32_32x32x16_bf16 v[196:211], v[68:71], v[84:87], v[196:211]
  v_mfma_f32_32x32x16_bf16 v[116:131], v[88:91], v[52:55], v[116:131]
  v_mfma_f32_32x32x16_bf16 v[164:179], v[88:91], v[68:71], v[164:179]
  s_waitcnt lgkmcnt(0)
  s_barrier
  v_mfma_f32_32x32x16_bf16 v[132:147], v[92:95], v[56:59], v[132:147]
  ds_read_b64_tr_b16 v[80:81], v10 offset:0
  ds_read_b64_tr_b16 v[82:83], v10 offset:256
  v_mfma_f32_32x32x16_bf16 v[180:195], v[92:95], v[72:75], v[180:195]
  ds_read_b64_tr_b16 v[84:85], v10 offset:4096
  ds_read_b64_tr_b16 v[86:87], v10 offset:4352
  v_mfma_f32_32x32x16_bf16 v[148:163], v[56:59], v[96:99], v[148:163]
  ds_read_b64_tr_b16 v[88:89], v10 offset:8192
  ds_read_b64_tr_b16 v[90:91], v10 offset:8448
  v_mfma_f32_32x32x16_bf16 v[196:211], v[72:75], v[96:99], v[196:211]
  ds_read_b128 v[16:19], v5 offset:0
  ds_read_b128 v[32:35], v5 offset:12288
  v_mfma_f32_32x32x16_bf16 v[116:131], v[100:103], v[56:59], v[116:131]
  ds_read_b128 v[20:23], v6 offset:0
  ds_read_b128 v[36:39], v6 offset:12288
  v_mfma_f32_32x32x16_bf16 v[164:179], v[100:103], v[72:75], v[164:179]
  v_mfma_f32_32x32x16_bf16 v[132:147], v[104:107], v[60:63], v[132:147]
  ds_read_b64_tr_b16 v[92:93], v10 offset:1024
  ds_read_b64_tr_b16 v[94:95], v10 offset:1280
  v_mfma_f32_32x32x16_bf16 v[180:195], v[104:107], v[76:79], v[180:195]
  ds_read_b64_tr_b16 v[96:97], v10 offset:5120
  ds_read_b64_tr_b16 v[98:99], v10 offset:5376
  v_mfma_f32_32x32x16_bf16 v[148:163], v[60:63], v[108:111], v[148:163]
  ds_read_b64_tr_b16 v[100:101], v10 offset:9216
  ds_read_b64_tr_b16 v[102:103], v10 offset:9472
  v_mfma_f32_32x32x16_bf16 v[196:211], v[76:79], v[108:111], v[196:211]
  ds_read_b128 v[24:27], v7 offset:0
  ds_read_b128 v[40:43], v7 offset:12288
  v_mfma_f32_32x32x16_bf16 v[116:131], v[112:115], v[60:63], v[116:131]
  ds_read_b128 v[28:31], v8 offset:0
  ds_read_b128 v[44:47], v8 offset:12288
  v_mfma_f32_32x32x16_bf16 v[164:179], v[112:115], v[76:79], v[164:179]
  s_waitcnt lgkmcnt(14)
  s_waitcnt lgkmcnt(12)
  v_mfma_f32_32x32x16_bf16 v[132:147], v[80:83], v[16:19], v[132:147]
  ds_read_b64_tr_b16 v[104:105], v10 offset:2048
  ds_read_b64_tr_b16 v[106:107], v10 offset:2304
  v_mfma_f32_32x32x16_bf16 v[180:195], v[80:83], v[32:35], v[180:195]
  ds_read_b64_tr_b16 v[108:109], v10 offset:6144
  ds_read_b64_tr_b16 v[110:111], v10 offset:6400
  v_mfma_f32_32x32x16_bf16 v[148:163], v[16:19], v[84:87], v[148:163]
  ds_read_b64_tr_b16 v[112:113], v10 offset:10240
  ds_read_b64_tr_b16 v[114:115], v10 offset:10496
  v_mfma_f32_32x32x16_bf16 v[196:211], v[32:35], v[84:87], v[196:211]
  v_mfma_f32_32x32x16_bf16 v[116:131], v[88:91], v[16:19], v[116:131]
  v_mfma_f32_32x32x16_bf16 v[164:179], v[88:91], v[32:35], v[164:179]
  s_waitcnt lgkmcnt(10)
  v_mfma_f32_32x32x16_bf16 v[132:147], v[92:95], v[20:23], v[132:147]
  ds_read_b64_tr_b16 v[80:81], v10 offset:3072
  ds_read_b64_tr_b16 v[82:83], v10 offset:3328
  v_mfma_f32_32x32x16_bf16 v[180:195], v[92:95], v[36:39], v[180:195]
  ds_read_b64_tr_b16 v[84:85], v10 offset:7168
  ds_read_b64_tr_b16 v[86:87], v10 offset:7424
  v_mfma_f32_32x32x16_bf16 v[148:163], v[20:23], v[96:99], v[148:163]
  ds_read_b64_tr_b16 v[88:89], v10 offset:11264
  ds_read_b64_tr_b16 v[90:91], v10 offset:11520
  v_mfma_f32_32x32x16_bf16 v[196:211], v[36:39], v[96:99], v[196:211]
  v_mfma_f32_32x32x16_bf16 v[116:131], v[100:103], v[20:23], v[116:131]
  v_mfma_f32_32x32x16_bf16 v[164:179], v[100:103], v[36:39], v[164:179]
  s_waitcnt lgkmcnt(0)
  s_barrier
  v_mfma_f32_32x32x16_bf16 v[132:147], v[104:107], v[24:27], v[132:147]
  ds_read_b64_tr_b16 v[92:93], v10 offset:12288
  ds_read_b64_tr_b16 v[94:95], v10 offset:12544
  v_mfma_f32_32x32x16_bf16 v[180:195], v[104:107], v[40:43], v[180:195]
  ds_read_b64_tr_b16 v[96:97], v10 offset:16384
  ds_read_b64_tr_b16 v[98:99], v10 offset:16640
  v_mfma_f32_32x32x16_bf16 v[148:163], v[24:27], v[108:111], v[148:163]
  ds_read_b64_tr_b16 v[100:101], v10 offset:20480
  ds_read_b64_tr_b16 v[102:103], v10 offset:20736
  v_mfma_f32_32x32x16_bf16 v[196:211], v[40:43], v[108:111], v[196:211]
  ds_read_b128 v[48:51], v5 offset:4096
  ds_read_b128 v[64:67], v5 offset:16384
  v_mfma_f32_32x32x16_bf16 v[116:131], v[112:115], v[24:27], v[116:131]
  ds_read_b128 v[52:55], v6 offset:4096
  ds_read_b128 v[68:71], v6 offset:16384
  v_mfma_f32_32x32x16_bf16 v[164:179], v[112:115], v[40:43], v[164:179]
  v_mfma_f32_32x32x16_bf16 v[132:147], v[80:83], v[28:31], v[132:147]
  ds_read_b64_tr_b16 v[104:105], v10 offset:13312
  ds_read_b64_tr_b16 v[106:107], v10 offset:13568
  v_mfma_f32_32x32x16_bf16 v[180:195], v[80:83], v[44:47], v[180:195]
  ds_read_b64_tr_b16 v[108:109], v10 offset:17408
  ds_read_b64_tr_b16 v[110:111], v10 offset:17664
  v_mfma_f32_32x32x16_bf16 v[148:163], v[28:31], v[84:87], v[148:163]
  ds_read_b64_tr_b16 v[112:113], v10 offset:21504
  ds_read_b64_tr_b16 v[114:115], v10 offset:21760
  v_mfma_f32_32x32x16_bf16 v[196:211], v[44:47], v[84:87], v[196:211]
  ds_read_b128 v[56:59], v7 offset:4096
  ds_read_b128 v[72:75], v7 offset:16384
  v_mfma_f32_32x32x16_bf16 v[116:131], v[88:91], v[28:31], v[116:131]
  ds_read_b128 v[60:63], v8 offset:4096
  ds_read_b128 v[76:79], v8 offset:16384
  v_mfma_f32_32x32x16_bf16 v[164:179], v[88:91], v[44:47], v[164:179]
  s_waitcnt lgkmcnt(14)
  s_waitcnt lgkmcnt(12)
  v_mfma_f32_32x32x16_bf16 v[132:147], v[92:95], v[48:51], v[132:147]
  ds_read_b64_tr_b16 v[80:81], v10 offset:14336
  ds_read_b64_tr_b16 v[82:83], v10 offset:14592
  v_and_b32 v13, 31, v0
  v_lshrrev_b32 v15, 5, v0
  v_lshlrev_b32 v15, 2, v15
  v_mfma_f32_32x32x16_bf16 v[180:195], v[92:95], v[64:67], v[180:195]
  ds_read_b64_tr_b16 v[84:85], v10 offset:18432
  ds_read_b64_tr_b16 v[86:87], v10 offset:18688
  v_sub_u32 v13, v13, v15
  v_subrev_u32 v16, 0, v13
  v_ashrrev_i32 v16, 31, v16
  v_mfma_f32_32x32x16_bf16 v[148:163], v[48:51], v[96:99], v[148:163]
  ds_read_b64_tr_b16 v[88:89], v10 offset:22528
  ds_read_b64_tr_b16 v[90:91], v10 offset:22784
  v_and_b32 v16, 0xff800000, v16
  v_subrev_u32 v17, 1, v13
  v_ashrrev_i32 v17, 31, v17
  v_mfma_f32_32x32x16_bf16 v[196:211], v[64:67], v[96:99], v[196:211]
  v_and_b32 v17, 0xff800000, v17
  v_subrev_u32 v18, 2, v13
  v_ashrrev_i32 v18, 31, v18
  v_mfma_f32_32x32x16_bf16 v[116:131], v[100:103], v[48:51], v[116:131]
  v_and_b32 v18, 0xff800000, v18
  v_subrev_u32 v19, 3, v13
  v_ashrrev_i32 v19, 31, v19
  v_mfma_f32_32x32x16_bf16 v[164:179], v[100:103], v[64:67], v[164:179]
  v_and_b32 v19, 0xff800000, v19
  v_subrev_u32 v20, 8, v13
  v_ashrrev_i32 v20, 31, v20
  s_lshl_b32 s82, s63, 6
  s_lshl_b32 s73, s62, 3
  s_add_u32 s82, s82, s73
  s_lshl_b32 s73, s60, 1
  s_add_u32 s82, s82, s73
  s_lshl_b32 s82, s82, 12
  s_add_u32 s82, s82, 1048576
  s_add_u32 s72, s82, 4096
  v_add_u32 v1, s75, v12
  s_mov_b32 s73, 0x3eb8aa3b
  ds_read_b64_tr_b16 v[92:93], v10 offset:15360
  ds_read_b64_tr_b16 v[94:95], v10 offset:15616
  ds_read_b64_tr_b16 v[96:97], v10 offset:19456
  ds_read_b64_tr_b16 v[98:99], v10 offset:19712
  ds_read_b64_tr_b16 v[100:101], v10 offset:23552
  ds_read_b64_tr_b16 v[102:103], v10 offset:23808
  s_waitcnt lgkmcnt(6)
  v_mfma_f32_32x32x16_bf16 v[132:147], v[104:107], v[52:55], v[132:147]
  v_and_b32 v20, 0xff800000, v20
  v_subrev_u32 v21, 9, v13
  v_ashrrev_i32 v21, 31, v21
  v_and_b32 v21, 0xff800000, v21
  v_subrev_u32 v22, 10, v13
  v_ashrrev_i32 v22, 31, v22
  v_and_b32 v22, 0xff800000, v22
  v_subrev_u32 v23, 11, v13
  v_mfma_f32_32x32x16_bf16 v[180:195], v[104:107], v[68:71], v[180:195]
  v_ashrrev_i32 v23, 31, v23
  v_and_b32 v23, 0xff800000, v23
  v_subrev_u32 v24, 16, v13
  v_ashrrev_i32 v24, 31, v24
  v_and_b32 v24, 0xff800000, v24
  v_subrev_u32 v25, 17, v13
  v_ashrrev_i32 v25, 31, v25
  v_and_b32 v25, 0xff800000, v25
  v_mfma_f32_32x32x16_bf16 v[132:147], v[80:83], v[56:59], v[132:147]
  v_subrev_u32 v26, 18, v13
  v_ashrrev_i32 v26, 31, v26
  v_and_b32 v26, 0xff800000, v26
  v_subrev_u32 v27, 19, v13
  v_ashrrev_i32 v27, 31, v27
  v_and_b32 v27, 0xff800000, v27
  v_subrev_u32 v28, 24, v13
  v_ashrrev_i32 v28, 31, v28
  v_mfma_f32_32x32x16_bf16 v[180:195], v[80:83], v[72:75], v[180:195]
  v_and_b32 v28, 0xff800000, v28
  v_subrev_u32 v29, 25, v13
  v_ashrrev_i32 v29, 31, v29
  v_and_b32 v29, 0xff800000, v29
  v_subrev_u32 v30, 26, v13
  v_ashrrev_i32 v30, 31, v30
  v_and_b32 v30, 0xff800000, v30
  v_subrev_u32 v31, 27, v13
  s_waitcnt lgkmcnt(0)
  v_mfma_f32_32x32x16_bf16 v[132:147], v[92:95], v[60:63], v[132:147]
  v_ashrrev_i32 v31, 31, v31
  v_and_b32 v31, 0xff800000, v31
  v_mov_b32 v32, 0x3f803f80
  v_mov_b32 v33, 0x3f803f80
  v_mov_b32 v34, 0x3f803f80
  v_mov_b32 v35, 0x3f803f80
  v_mov_b32 v36, 0x3f803f80
  v_mov_b32 v37, 0x3f803f80
  v_mfma_f32_32x32x16_bf16 v[180:195], v[92:95], v[76:79], v[180:195]
  v_mov_b32 v38, 0x3f803f80
  v_mov_b32 v39, 0x3f803f80
  v_mov_b32 v40, 0x3f803f80
  v_mov_b32 v41, 0x3f803f80
  v_mov_b32 v42, 0x3f803f80
  v_mov_b32 v43, 0x3f803f80
  v_mov_b32 v44, 0x3f803f80
  v_mov_b32 v45, 0x3f803f80
  v_mov_b32 v46, 0x3f803f80
  v_mov_b32 v47, 0x3f803f80
  v_mfma_f32_32x32x16_bf16 v[148:163], v[52:55], v[108:111], v[148:163]
  v_mfma_f32_32x32x16_bf16 v[196:211], v[68:71], v[108:111], v[196:211]
  s_nop 7
  s_nop 1
  v_mfma_f32_32x32x16_bf16 v[148:163], v[56:59], v[84:87], v[148:163]
  v_cvt_pk_bf16_f32 v248, v132, v133
  v_cvt_pk_bf16_f32 v249, v134, v135
  v_cvt_pk_bf16_f32 v250, v136, v137
  v_cvt_pk_bf16_f32 v251, v138, v139
  v_cvt_pk_bf16_f32 v252, v140, v141
  v_mfma_f32_32x32x16_bf16 v[196:211], v[72:75], v[84:87], v[196:211]
  v_cvt_pk_bf16_f32 v253, v142, v143
  v_cvt_pk_bf16_f32 v254, v144, v145
  v_cvt_pk_bf16_f32 v255, v146, v147
  buffer_store_dwordx4 v[248:251], v12, s[24:27], s82 offen offset:0 sc1
  buffer_store_dwordx4 v[252:255], v12, s[24:27], s82 offen offset:1024 sc1
  v_mfma_f32_32x32x16_bf16 v[148:163], v[60:63], v[96:99], v[148:163]
  ds_write_b128 v1, v[248:251] offset:0
  ds_write_b128 v1, v[252:255] offset:1024
  v_cvt_pk_bf16_f32 v4, v180, v181
  v_cvt_pk_bf16_f32 v5, v182, v183
  v_cvt_pk_bf16_f32 v6, v184, v185
  v_mfma_f32_32x32x16_bf16 v[196:211], v[76:79], v[96:99], v[196:211]
  v_cvt_pk_bf16_f32 v7, v186, v187
  v_cvt_pk_bf16_f32 v8, v188, v189
  v_cvt_pk_bf16_f32 v9, v190, v191
  v_cvt_pk_bf16_f32 v10, v192, v193
  v_cvt_pk_bf16_f32 v11, v194, v195
  v_mfma_f32_32x32x16_bf16 v[116:131], v[112:115], v[52:55], v[116:131]
  buffer_store_dwordx4 v[4:7], v12, s[24:27], s72 offen offset:0 sc1
  buffer_store_dwordx4 v[8:11], v12, s[24:27], s72 offen offset:1024 sc1
  ds_write_b128 v1, v[4:7] offset:12288
  ds_write_b128 v1, v[8:11] offset:13312
  v_mfma_f32_32x32x16_bf16 v[164:179], v[112:115], v[68:71], v[164:179]
  v_mfma_f32_32x32x16_bf16 v[116:131], v[88:91], v[56:59], v[116:131]
  v_cvt_pk_bf16_f32 v132, v148, v149
  v_cvt_pk_bf16_f32 v133, v150, v151
  v_cvt_pk_bf16_f32 v134, v152, v153
  v_cvt_pk_bf16_f32 v135, v154, v155
  v_cvt_pk_bf16_f32 v136, v156, v157
  v_cvt_pk_bf16_f32 v137, v158, v159
  v_mfma_f32_32x32x16_bf16 v[164:179], v[88:91], v[72:75], v[164:179]
  v_cvt_pk_bf16_f32 v138, v160, v161
  v_cvt_pk_bf16_f32 v139, v162, v163
  buffer_store_dwordx4 v[132:135], v12, s[24:27], s82 offen offset:2048 sc1
  buffer_store_dwordx4 v[136:139], v12, s[24:27], s82 offen offset:3072 sc1
  ds_write_b128 v1, v[132:135] offset:2048
  ds_write_b128 v1, v[136:139] offset:3072
  v_mfma_f32_32x32x16_bf16 v[116:131], v[100:103], v[60:63], v[116:131]
  v_cvt_pk_bf16_f32 v180, v196, v197
  v_cvt_pk_bf16_f32 v181, v198, v199
  v_cvt_pk_bf16_f32 v182, v200, v201
  v_cvt_pk_bf16_f32 v183, v202, v203
  v_cvt_pk_bf16_f32 v184, v204, v205
  v_cvt_pk_bf16_f32 v185, v206, v207
  v_mfma_f32_32x32x16_bf16 v[164:179], v[100:103], v[76:79], v[164:179]
  v_cvt_pk_bf16_f32 v186, v208, v209
  v_cvt_pk_bf16_f32 v187, v210, v211
  buffer_store_dwordx4 v[180:183], v12, s[24:27], s72 offen offset:2048 sc1
  buffer_store_dwordx4 v[184:187], v12, s[24:27], s72 offen offset:3072 sc1
  ds_write_b128 v1, v[180:183] offset:14336
  ds_write_b128 v1, v[184:187] offset:15360
  s_nop 3
  s_nop 7
  v_mul_f32 v116, s73, v116
  v_mul_f32 v117, s73, v117
  v_mul_f32 v118, s73, v118
  v_mul_f32 v119, s73, v119
  v_mul_f32 v120, s73, v120
  v_mul_f32 v121, s73, v121
  v_mul_f32 v122, s73, v122
  v_mul_f32 v123, s73, v123
  v_mul_f32 v124, s73, v124
  v_mul_f32 v125, s73, v125
  v_mul_f32 v126, s73, v126
  v_mul_f32 v127, s73, v127
  v_mul_f32 v128, s73, v128
  v_mul_f32 v129, s73, v129
  v_mul_f32 v130, s73, v130
  v_mul_f32 v131, s73, v131
  v_cvt_pk_bf16_f32 v148, v116, v117
  v_cvt_pk_bf16_f32 v149, v118, v119
  v_cvt_pk_bf16_f32 v150, v120, v121
  v_cvt_pk_bf16_f32 v151, v122, v123
  v_cvt_pk_bf16_f32 v152, v124, v125
  v_cvt_pk_bf16_f32 v153, v126, v127
  v_cvt_pk_bf16_f32 v154, v128, v129
  v_cvt_pk_bf16_f32 v155, v130, v131
  ds_write_b128 v1, v[148:151] offset:8192
  ds_write_b128 v1, v[152:155] offset:9216
  v_mul_f32 v164, s73, v164
  v_mul_f32 v165, s73, v165
  v_mul_f32 v166, s73, v166
  v_mul_f32 v167, s73, v167
  v_mul_f32 v168, s73, v168
  v_mul_f32 v169, s73, v169
  v_mul_f32 v170, s73, v170
  v_mul_f32 v171, s73, v171
  v_mul_f32 v172, s73, v172
  v_mul_f32 v173, s73, v173
  v_mul_f32 v174, s73, v174
  v_mul_f32 v175, s73, v175
  v_mul_f32 v176, s73, v176
  v_mul_f32 v177, s73, v177
  v_mul_f32 v178, s73, v178
  v_mul_f32 v179, s73, v179
  v_cvt_pk_bf16_f32 v196, v164, v165
  v_cvt_pk_bf16_f32 v197, v166, v167
  v_cvt_pk_bf16_f32 v198, v168, v169
  v_cvt_pk_bf16_f32 v199, v170, v171
  v_cvt_pk_bf16_f32 v200, v172, v173
  v_cvt_pk_bf16_f32 v201, v174, v175
  v_cvt_pk_bf16_f32 v202, v176, v177
  v_cvt_pk_bf16_f32 v203, v178, v179
  ds_write_b128 v1, v[196:199] offset:20480
  ds_write_b128 v1, v[200:203] offset:21504
  s_lshl_b32 s82, s62, 5
  s_add_u32 s82, s82, s63
  s_lshl_b32 s82, s82, 7
  s_lshl_b32 s74, s60, 3
  s_add_u32 s82, s82, s74
  s_add_u32 s82, s82, 16384
L_B1:
  s_waitcnt lgkmcnt(0)
  s_barrier
  v_mov_b32 v15, 10240
  ds_read_b32 v14, v15
  s_mul_i32 s73, s61, 12288
  v_add_u32 v13, s73, v12
  ds_read_b128 v[248:251], v13 offset:8192
  ds_read_b128 v[252:255], v13 offset:9216
  s_mul_i32 s71, s61, 12288
  s_mov_b32 s72, 0
  v_add_u32 v1, s71, v12
  ds_read_b128 v[56:59], v1 offset:0
  ds_read_b128 v[60:63], v1 offset:1024
  s_sub_u32 s73, s72, s71
  s_mov_b32 s77, s61
  s_waitcnt lgkmcnt(0)
  v_readfirstlane_b32 s69, v14
  v_mfma_f32_32x32x16_bf16 v[160:175], v[56:59], v[248:251], v[16:31]
  v_mfma_f32_32x32x16_bf16 v[176:191], v[60:63], v[252:255], v[16:31]
  s_mov_b64 exec, s[78:79]
  ds_read_b128 v[32:35], v1 offset:2048
  ds_read_b128 v[36:39], v1 offset:3072
  s_mov_b64 exec, -1
  s_mov_b64 exec, s[78:79]
  ds_read_b128 v[40:43], v1 offset:2304
  ds_read_b128 v[44:47], v1 offset:3328
  s_mov_b64 exec, -1
  v_add_u32 v1, s73, v1
  ds_read_b128 v[56:59], v1 offset:0
  ds_read_b128 v[60:63], v1 offset:1024
  s_waitcnt lgkmcnt(2)
  v_exp_f32 v160, v160
  v_exp_f32 v161, v161
  v_exp_f32 v162, v162
  v_exp_f32 v163, v163
  v_exp_f32 v164, v164
  v_exp_f32 v165, v165
  v_exp_f32 v166, v166
  v_exp_f32 v167, v167
  v_cvt_pk_bf16_f32 v48, v160, v161
  v_cvt_pk_bf16_f32 v49, v162, v163
  v_cvt_pk_bf16_f32 v50, v164, v165
  v_cvt_pk_bf16_f32 v51, v166, v167
  v_exp_f32 v168, v168
  s_waitcnt lgkmcnt(0)
  v_exp_f32 v169, v169
  v_mfma_f32_32x32x16_bf16 v[216:231], v[32:35], v[48:51], v[216:231]
  v_exp_f32 v170, v170
  v_exp_f32 v171, v171
  v_exp_f32 v172, v172
  v_exp_f32 v173, v173
  v_exp_f32 v174, v174
  v_exp_f32 v175, v175
  v_cvt_pk_bf16_f32 v52, v168, v169
  v_cvt_pk_bf16_f32 v53, v170, v171
  v_cvt_pk_bf16_f32 v54, v172, v173
  v_cvt_pk_bf16_f32 v55, v174, v175
  s_cmp_ge_u32 s60, 4
  s_cbranch_scc1 L_KVF_DONE
  s_waitcnt vmcnt(0)
  v_lshlrev_b32 v13, 2, v0
  v_mov_b32 v14, s69
  s_mov_b64 exec, 3
  buffer_store_dword v14, v13, s[24:27], s82 offen sc1
  s_mov_b64 exec, -1
L_KVF_DONE:
  s_cmp_eq_u32 s77, 0
  s_cbranch_scc1 L_OWN_LAST
  s_sub_u32 s77, s77, 1
L_OWN_LOOP:
  v_exp_f32 v176, v176
  v_exp_f32 v177, v177
  v_mfma_f32_32x32x16_bf16 v[216:231], v[36:39], v[52:55], v[216:231]
  v_exp_f32 v178, v178
  v_exp_f32 v179, v179
  s_mov_b64 exec, s[78:79]
  ds_read_b128 v[32:35], v1 offset:2048
  ds_read_b128 v[36:39], v1 offset:3072
  s_mov_b64 exec, -1
  v_exp_f32 v180, v180
  v_exp_f32 v181, v181
  v_mfma_f32_32x32x16_bf16 v[160:175], v[56:59], v[248:251], 0
  ds_read_b128 v[56:59], v1 offset:12288
  v_exp_f32 v182, v182
  v_exp_f32 v183, v183
  v_cvt_pk_bf16_f32 v48, v176, v177
  v_cvt_pk_bf16_f32 v49, v178, v179
  v_cvt_pk_bf16_f32 v50, v180, v181
  v_cvt_pk_bf16_f32 v51, v182, v183
  v_exp_f32 v184, v184
  s_waitcnt lgkmcnt(3)
  v_exp_f32 v185, v185
  v_mfma_f32_32x32x16_bf16 v[232:247], v[40:43], v[48:51], v[232:247]
  v_exp_f32 v186, v186
  v_exp_f32 v187, v187
  v_exp_f32 v188, v188
  v_exp_f32 v189, v189
  v_exp_f32 v190, v190
  v_exp_f32 v191, v191
  v_cvt_pk_bf16_f32 v52, v184, v185
  v_cvt_pk_bf16_f32 v53, v186, v187
  v_cvt_pk_bf16_f32 v54, v188, v189
  v_cvt_pk_bf16_f32 v55, v190, v191
  v_exp_f32 v160, v160
  v_exp_f32 v161, v161
  v_mfma_f32_32x32x16_bf16 v[232:247], v[44:47], v[52:55], v[232:247]
  v_exp_f32 v162, v162
  v_exp_f32 v163, v163
  s_mov_b64 exec, s[78:79]
  ds_read_b128 v[40:43], v1 offset:2304
  ds_read_b128 v[44:47], v1 offset:3328
  s_mov_b64 exec, -1
  v_exp_f32 v164, v164
  v_exp_f32 v165, v165
  v_mfma_f32_32x32x16_bf16 v[176:191], v[60:63], v[252:255], 0
  ds_read_b128 v[60:63], v1 offset:13312
  v_exp_f32 v166, v166
  v_exp_f32 v167, v167
  v_cvt_pk_bf16_f32 v48, v160, v161
  v_cvt_pk_bf16_f32 v49, v162, v163
  v_cvt_pk_bf16_f32 v50, v164, v165
  v_cvt_pk_bf16_f32 v51, v166, v167
  v_exp_f32 v168, v168
  s_waitcnt lgkmcnt(3)
  v_exp_f32 v169, v169
  v_mfma_f32_32x32x16_bf16 v[216:231], v[32:35], v[48:51], v[216:231]
  v_exp_f32 v170, v170
  v_exp_f32 v171, v171
  v_exp_f32 v172, v172
  v_exp_f32 v173, v173
  v_exp_f32 v174, v174
  v_exp_f32 v175, v175
  v_cvt_pk_bf16_f32 v52, v168, v169
  v_cvt_pk_bf16_f32 v53, v170, v171
  v_cvt_pk_bf16_f32 v54, v172, v173
  v_cvt_pk_bf16_f32 v55, v174, v175
  v_add_u32 v1, 12288, v1
  s_sub_u32 s77, s77, 1
  s_cbranch_scc0 L_OWN_LOOP
L_OWN_LAST:
  v_exp_f32 v176, v176
  v_exp_f32 v177, v177
  v_mfma_f32_32x32x16_bf16 v[216:231], v[36:39], v[52:55], v[216:231]
  v_exp_f32 v178, v178
  v_exp_f32 v179, v179
  v_exp_f32 v180, v180
  v_exp_f32 v181, v181
  v_exp_f32 v182, v182
  v_exp_f32 v183, v183
  v_cvt_pk_bf16_f32 v48, v176, v177
  v_cvt_pk_bf16_f32 v49, v178, v179
  v_cvt_pk_bf16_f32 v50, v180, v181
  v_cvt_pk_bf16_f32 v51, v182, v183
  v_exp_f32 v184, v184
  s_waitcnt lgkmcnt(0)
  v_exp_f32 v185, v185
  v_mfma_f32_32x32x16_bf16 v[232:247], v[40:43], v[48:51], v[232:247]
  v_exp_f32 v186, v186
  v_exp_f32 v187, v187
  v_exp_f32 v188, v188
  v_exp_f32 v189, v189
  v_exp_f32 v190, v190
  v_exp_f32 v191, v191
  v_cvt_pk_bf16_f32 v52, v184, v185
  v_cvt_pk_bf16_f32 v53, v186, v187
  v_cvt_pk_bf16_f32 v54, v188, v189
  v_cvt_pk_bf16_f32 v55, v190, v191
  s_nop 1
  v_mfma_f32_32x32x16_bf16 v[232:247], v[44:47], v[52:55], v[232:247]
  s_cmp_gt_u32 s61, 3
  s_cbranch_scc0 L_ROLE_LO
L_HALO_BAR:
  s_barrier
  s_cmp_ge_u32 s61, 4
  s_cbranch_scc1 L_LATE_S
  v_mov_b32 v128, -1
  v_mov_b32 v129, -1
  v_mov_b32 v130, -1
  v_mov_b32 v131, -1
  s_lshl_b32 s73, s66, 1
  s_add_u32 s73, s73, s64
  s_lshl_b32 s73, s73, 5
  s_lshl_b32 s74, s65, 1
  s_add_u32 s73, s73, s74
  s_lshl_b32 s73, s73, 10
  s_add_u32 s73, s73, 16777216
  buffer_store_dwordx4 v[128:131], v12, s[24:27], s73 offen offset:0 sc1
  buffer_store_dwordx4 v[128:131], v12, s[24:27], s73 offen offset:1024 sc1
L_LATE_E:
  s_cmp_eq_u32 s62, 0
  s_cbranch_scc1 L_P2_EPI
  s_mul_i32 s71, s61, 12288
  s_add_u32 s71, s71, 4096
  s_add_u32 s72, s71, 12288
  s_sub_u32 s75, 7, s61
  v_add_u32 v1, s71, v12
  ds_read_b128 v[56:59], v1 offset:0
  ds_read_b128 v[60:63], v1 offset:1024
  s_sub_u32 s73, s72, s71
  s_mov_b32 s77, s75
  s_waitcnt lgkmcnt(0)
  v_mfma_f32_32x32x16_bf16 v[160:175], v[56:59], v[248:251], v[144:159]
  v_mfma_f32_32x32x16_bf16 v[176:191], v[60:63], v[252:255], v[144:159]
  s_mov_b64 exec, s[78:79]
  ds_read_b128 v[32:35], v1 offset:2048
  ds_read_b128 v[36:39], v1 offset:3072
  s_mov_b64 exec, -1
  s_mov_b64 exec, s[78:79]
  ds_read_b128 v[40:43], v1 offset:2304
  ds_read_b128 v[44:47], v1 offset:3328
  s_mov_b64 exec, -1
  v_add_u32 v1, s73, v1
  ds_read_b128 v[56:59], v1 offset:0
  ds_read_b128 v[60:63], v1 offset:1024
  s_waitcnt lgkmcnt(2)
  v_exp_f32 v160, v160
  v_exp_f32 v161, v161
  v_exp_f32 v162, v162
  v_exp_f32 v163, v163
  v_exp_f32 v164, v164
  v_exp_f32 v165, v165
  v_exp_f32 v166, v166
  v_exp_f32 v167, v167
  v_cvt_pk_bf16_f32 v48, v160, v161
  v_cvt_pk_bf16_f32 v49, v162, v163
  v_cvt_pk_bf16_f32 v50, v164, v165
  v_cvt_pk_bf16_f32 v51, v166, v167
  v_exp_f32 v168, v168
  s_waitcnt lgkmcnt(0)
  v_exp_f32 v169, v169
  v_mfma_f32_32x32x16_bf16 v[216:231], v[32:35], v[48:51], v[216:231]
  v_exp_f32 v170, v170
  v_exp_f32 v171, v171
  v_exp_f32 v172, v172
  v_exp_f32 v173, v173
  v_exp_f32 v174, v174
  v_exp_f32 v175, v175
  v_cvt_pk_bf16_f32 v52, v168, v169
  v_cvt_pk_bf16_f32 v53, v170, v171
  v_cvt_pk_bf16_f32 v54, v172, v173
  v_cvt_pk_bf16_f32 v55, v174, v175
  s_cmp_eq_u32 s77, 0
  s_cbranch_scc1 L_HALO_LAST
  s_sub_u32 s77, s77, 1
L_HALO_LOOP:
  v_exp_f32 v176, v176
  v_exp_f32 v177, v177
  v_mfma_f32_32x32x16_bf16 v[216:231], v[36:39], v[52:55], v[216:231]
  v_exp_f32 v178, v178
  v_exp_f32 v179, v179
  s_mov_b64 exec, s[78:79]
  ds_read_b128 v[32:35], v1 offset:2048
  ds_read_b128 v[36:39], v1 offset:3072
  s_mov_b64 exec, -1
  v_exp_f32 v180, v180
  v_exp_f32 v181, v181
  v_mfma_f32_32x32x16_bf16 v[160:175], v[56:59], v[248:251], 0
  ds_read_b128 v[56:59], v1 offset:12288
  v_exp_f32 v182, v182
  v_exp_f32 v183, v183
  v_cvt_pk_bf16_f32 v48, v176, v177
  v_cvt_pk_bf16_f32 v49, v178, v179
  v_cvt_pk_bf16_f32 v50, v180, v181
  v_cvt_pk_bf16_f32 v51, v182, v183
  v_exp_f32 v184, v184
  s_waitcnt lgkmcnt(3)
  v_exp_f32 v185, v185
  v_mfma_f32_32x32x16_bf16 v[232:247], v[40:43], v[48:51], v[232:247]
  v_exp_f32 v186, v186
  v_exp_f32 v187, v187
  v_exp_f32 v188, v188
  v_exp_f32 v189, v189
  v_exp_f32 v190, v190
  v_exp_f32 v191, v191
  v_cvt_pk_bf16_f32 v52, v184, v185
  v_cvt_pk_bf16_f32 v53, v186, v187
  v_cvt_pk_bf16_f32 v54, v188, v189
  v_cvt_pk_bf16_f32 v55, v190, v191
  v_exp_f32 v160, v160
  v_exp_f32 v161, v161
  v_mfma_f32_32x32x16_bf16 v[232:247], v[44:47], v[52:55], v[232:247]
  v_exp_f32 v162, v162
  v_exp_f32 v163, v163
  s_mov_b64 exec, s[78:79]
  ds_read_b128 v[40:43], v1 offset:2304
  ds_read_b128 v[44:47], v1 offset:3328
  s_mov_b64 exec, -1
  v_exp_f32 v164, v164
  v_exp_f32 v165, v165
  v_mfma_f32_32x32x16_bf16 v[176:191], v[60:63], v[252:255], 0
  ds_read_b128 v[60:63], v1 offset:13312
  v_exp_f32 v166, v166
  v_exp_f32 v167, v167
  v_cvt_pk_bf16_f32 v48, v160, v161
  v_cvt_pk_bf16_f32 v49, v162, v163
  v_cvt_pk_bf16_f32 v50, v164, v165
  v_cvt_pk_bf16_f32 v51, v166, v167
  v_exp_f32 v168, v168
  s_waitcnt lgkmcnt(3)
  v_exp_f32 v169, v169
  v_mfma_f32_32x32x16_bf16 v[216:231], v[32:35], v[48:51], v[216:231]
  v_exp_f32 v170, v170
  v_exp_f32 v171, v171
  v_exp_f32 v172, v172
  v_exp_f32 v173, v173
  v_exp_f32 v174, v174
  v_exp_f32 v175, v175
  v_cvt_pk_bf16_f32 v52, v168, v169
  v_cvt_pk_bf16_f32 v53, v170, v171
  v_cvt_pk_bf16_f32 v54, v172, v173
  v_cvt_pk_bf16_f32 v55, v174, v175
  v_add_u32 v1, 12288, v1
  s_sub_u32 s77, s77, 1
  s_cbranch_scc0 L_HALO_LOOP
L_HALO_LAST:
  v_exp_f32 v176, v176
  v_exp_f32 v177, v177
  v_mfma_f32_32x32x16_bf16 v[216:231], v[36:39], v[52:55], v[216:231]
  v_exp_f32 v178, v178
  v_exp_f32 v179, v179
  v_exp_f32 v180, v180
  v_exp_f32 v181, v181
  v_exp_f32 v182, v182
  v_exp_f32 v183, v183
  v_cvt_pk_bf16_f32 v48, v176, v177
  v_cvt_pk_bf16_f32 v49, v178, v179
  v_cvt_pk_bf16_f32 v50, v180, v181
  v_cvt_pk_bf16_f32 v51, v182, v183
  v_exp_f32 v184, v184
  s_waitcnt lgkmcnt(0)
  v_exp_f32 v185, v185
  v_mfma_f32_32x32x16_bf16 v[232:247], v[40:43], v[48:51], v[232:247]
  v_exp_f32 v186, v186
  v_exp_f32 v187, v187
  v_exp_f32 v188, v188
  v_exp_f32 v189, v189
  v_exp_f32 v190, v190
  v_exp_f32 v191, v191
  v_cvt_pk_bf16_f32 v52, v184, v185
  v_cvt_pk_bf16_f32 v53, v186, v187
  v_cvt_pk_bf16_f32 v54, v188, v189
  v_cvt_pk_bf16_f32 v55, v190, v191
  s_nop 1
  v_mfma_f32_32x32x16_bf16 v[232:247], v[44:47], v[52:55], v[232:247]
L_P2_EPI:
  s_mov_b32 s71, 0x1f800000
  s_mov_b32 s72, 0x5f800000
  s_lshl_b32 s82, s66, 1
  s_add_u32 s82, s82, s64
  s_lshl_b32 s82, s82, 5
  s_lshl_b32 s74, s65, 1
  s_add_u32 s82, s82, s74
  s_lshl_b32 s82, s82, 10
  s_add_u32 s82, s82, 16777216
  s_lshl_b32 s73, s66, 2
  s_lshr_b32 s74, s63, 3
  s_add_u32 s73, s73, s74
  s_lshl_b32 s73, s73, 7
  s_and_b32 s74, s63, 7
  s_lshl_b32 s74, s74, 2
  s_add_u32 s73, s73, s74
  s_add_u32 s51, s73, 65536
  s_nop 2
  v_mul_f32 v13, 0, v216
  v_fmac_f32 v13, 0, v217
  v_fmac_f32 v13, 0, v218
  v_fmac_f32 v13, 0, v219
  v_fmac_f32 v13, 0, v220
  v_fmac_f32 v13, 0, v221
  v_fmac_f32 v13, 0, v222
  v_fmac_f32 v13, 0, v223
  v_cmp_nle_f32 vcc, s71, v224
  s_mov_b64 s[74:75], vcc
  v_cmp_nge_f32 vcc, s72, v224
  s_or_b64 s[74:75], s[74:75], vcc
  v_cmp_u_f32 vcc, v13, v13
  s_or_b64 s[74:75], s[74:75], vcc
  s_cmp_lg_u64 s[74:75], 0
  s_cselect_b32 s73, 1, 0
  s_or_b32 s81, s81, s73
  v_mul_f32 v13, 0, v232
  v_fmac_f32 v13, 0, v233
  v_fmac_f32 v13, 0, v234
  v_fmac_f32 v13, 0, v235
  v_fmac_f32 v13, 0, v236
  v_fmac_f32 v13, 0, v237
  v_fmac_f32 v13, 0, v238
  v_fmac_f32 v13, 0, v239
  v_cmp_nle_f32 vcc, s71, v240
  s_mov_b64 s[74:75], vcc
  v_cmp_nge_f32 vcc, s72, v240
  s_or_b64 s[74:75], s[74:75], vcc
  v_cmp_u_f32 vcc, v13, v13
  s_or_b64 s[74:75], s[74:75], vcc
  s_cmp_lg_u64 s[74:75], 0
  s_cselect_b32 s73, 2, 0
  s_or_b32 s81, s81, s73
  s_cmp_lg_u32 s81, 0
  s_cbranch_scc1 L_FB_ENTRY
L_NOFB:
  s_cmp_ge_u32 s60, 4
  s_cbranch_scc1 L_NOSENT0
  s_waitcnt vmcnt(0)
  s_branch L_NOSENT
L_NOSENT0:
L_NOSENT:
  v_rcp_f32 v13, v224
  v_rcp_f32 v14, v240
  v_mul_f32 v216, v216, v13
  v_mul_f32 v217, v217, v13
  v_mul_f32 v218, v218, v13
  v_mul_f32 v219, v219, v13
  v_mul_f32 v220, v220, v13
  v_mul_f32 v221, v221, v13
  v_mul_f32 v222, v222, v13
  v_mul_f32 v223, v223, v13
  v_cvt_pk_bf16_f32 v224, v216, v217
  v_cvt_pk_bf16_f32 v225, v218, v219
  v_cvt_pk_bf16_f32 v226, v220, v221
  v_cvt_pk_bf16_f32 v227, v222, v223
  v_min_u32 v224, -2, v224
  v_min_u32 v225, -2, v225
  v_min_u32 v226, -2, v226
  v_min_u32 v227, -2, v227
  buffer_store_dwordx4 v[224:227], v12, s[24:27], s82 offen offset:0 sc1
  v_mul_f32 v232, v232, v14
  v_mul_f32 v233, v233, v14
  v_mul_f32 v234, v234, v14
  v_mul_f32 v235, v235, v14
  v_mul_f32 v236, v236, v14
  v_mul_f32 v237, v237, v14
  v_mul_f32 v238, v238, v14
  v_mul_f32 v239, v239, v14
  v_cvt_pk_bf16_f32 v240, v232, v233
  v_cvt_pk_bf16_f32 v241, v234, v235
  v_cvt_pk_bf16_f32 v242, v236, v237
  v_cvt_pk_bf16_f32 v243, v238, v239
  v_min_u32 v240, -2, v240
  v_min_u32 v241, -2, v241
  v_min_u32 v242, -2, v242
  v_min_u32 v243, -2, v243
  buffer_store_dwordx4 v[240:243], v12, s[24:27], s82 offen offset:1024 sc1
  s_cmp_ge_u32 s60, 4
  s_cbranch_scc1 L_NOHINT
  v_lshlrev_b32 v13, 7, v0
  v_mov_b32 v14, s69
  s_mov_b64 exec, 1
  buffer_store_dword v14, v13, s[24:27], s51 offen sc1
  s_mov_b64 exec, -1
L_NOHINT:
  v_lshrrev_b32 v1, 5, v0
  v_lshlrev_b32 v1, 9, v1
  v_bfe_u32 v2, v0, 2, 2
  v_lshl_add_u32 v1, v2, 7, v1
  v_bfe_u32 v2, v0, 3, 1
  v_lshl_add_u32 v1, v2, 6, v1
  v_bfe_u32 v2, v0, 4, 1
  v_lshl_add_u32 v1, v2, 5, v1
  v_and_b32 v2, 3, v0
  v_lshl_add_u32 v1, v2, 3, v1
  s_lshl_b32 s73, s45, 14
  s_add_u32 s73, s73, 98304
  s_mul_i32 s74, s45, 24576
  v_xor_b32 v2, 64, v1
  v_add_u32 v244, s73, v1
  v_add_u32 v245, s73, v2
  v_add_u32 v246, s74, v1
  v_add_u32 v247, s74, v2
  ds_read_b64_tr_b16 v[16:17], v244 offset:0
  ds_read_b64_tr_b16 v[18:19], v244 offset:1024
  ds_read_b64_tr_b16 v[20:21], v245 offset:0
  ds_read_b64_tr_b16 v[22:23], v245 offset:1024
  ds_read_b64_tr_b16 v[24:25], v244 offset:2048
  ds_read_b64_tr_b16 v[26:27], v244 offset:3072
  ds_read_b64_tr_b16 v[28:29], v245 offset:2048
  ds_read_b64_tr_b16 v[30:31], v245 offset:3072
  ds_read_b64_tr_b16 v[32:33], v244 offset:4096
  ds_read_b64_tr_b16 v[34:35], v244 offset:5120
  ds_read_b64_tr_b16 v[36:37], v245 offset:4096
  ds_read_b64_tr_b16 v[38:39], v245 offset:5120
  ds_read_b64_tr_b16 v[40:41], v244 offset:6144
  ds_read_b64_tr_b16 v[42:43], v244 offset:7168
  ds_read_b64_tr_b16 v[44:45], v245 offset:6144
  ds_read_b64_tr_b16 v[46:47], v245 offset:7168
  ds_read_b64_tr_b16 v[48:49], v244 offset:8192
  ds_read_b64_tr_b16 v[50:51], v244 offset:9216
  ds_read_b64_tr_b16 v[52:53], v245 offset:8192
  ds_read_b64_tr_b16 v[54:55], v245 offset:9216
  ds_read_b64_tr_b16 v[56:57], v244 offset:10240
  ds_read_b64_tr_b16 v[58:59], v244 offset:11264
  ds_read_b64_tr_b16 v[60:61], v245 offset:10240
  ds_read_b64_tr_b16 v[62:63], v245 offset:11264
  ds_read_b64_tr_b16 v[64:65], v244 offset:12288
  ds_read_b64_tr_b16 v[66:67], v244 offset:13312
  ds_read_b64_tr_b16 v[68:69], v245 offset:12288
  ds_read_b64_tr_b16 v[70:71], v245 offset:13312
  ds_read_b64_tr_b16 v[72:73], v244 offset:14336
  ds_read_b64_tr_b16 v[74:75], v244 offset:15360
  ds_read_b64_tr_b16 v[76:77], v245 offset:14336
  ds_read_b64_tr_b16 v[78:79], v245 offset:15360
  s_lshl_b32 s72, s50, 2
  s_add_u32 s72, s72, s45
  s_lshl_b32 s72, s72, 7
  s_add_u32 s72, s72, 65536
  s_lshl_b32 s71, s50, 1
  s_add_u32 s71, s71, s48
  s_lshl_b32 s71, s71, 5
  s_lshl_b32 s74, s49, 4
  s_add_u32 s71, s71, s74
  s_lshl_b32 s71, s71, 10
  s_add_u32 s71, s71, 16777216
  s_cmp_eq_u32 s44, 0
  s_cbranch_scc0 L_P3_EARLY
L_P3_LATE:
  v_and_b32 v13, 7, v0
  v_lshlrev_b32 v13, 2, v13
  buffer_load_dword v14, v13, s[24:27], s72 offen sc1
  v_mov_b32 v212, 0
  v_mov_b32 v213, 0
  v_mov_b32 v214, 0
  v_mov_b32 v215, 0
  v_mov_b32 v216, 0
  v_mov_b32 v217, 0
  v_mov_b32 v218, 0
  v_mov_b32 v219, 0
  v_dot2_f32_bf16 v212, v96, v208, v212
  v_dot2_f32_bf16 v213, v100, v208, v213
  v_dot2_f32_bf16 v214, v104, v208, v214
  v_dot2_f32_bf16 v215, v108, v208, v215
  v_dot2_f32_bf16 v216, v112, v208, v216
  v_dot2_f32_bf16 v217, v116, v208, v217
  v_dot2_f32_bf16 v218, v120, v208, v218
  v_dot2_f32_bf16 v219, v124, v208, v219
  v_dot2_f32_bf16 v212, v97, v209, v212
  v_dot2_f32_bf16 v213, v101, v209, v213
  v_dot2_f32_bf16 v214, v105, v209, v214
  v_dot2_f32_bf16 v215, v109, v209, v215
  v_dot2_f32_bf16 v216, v113, v209, v216
  v_dot2_f32_bf16 v217, v117, v209, v217
  v_dot2_f32_bf16 v218, v121, v209, v218
  v_dot2_f32_bf16 v219, v125, v209, v219
  v_dot2_f32_bf16 v212, v98, v210, v212
  v_dot2_f32_bf16 v213, v102, v210, v213
  v_dot2_f32_bf16 v214, v106, v210, v214
  v_dot2_f32_bf16 v215, v110, v210, v215
  v_dot2_f32_bf16 v216, v114, v210, v216
  v_dot2_f32_bf16 v217, v118, v210, v217
  v_dot2_f32_bf16 v218, v122, v210, v218
  v_dot2_f32_bf16 v219, v126, v210, v219
  v_dot2_f32_bf16 v212, v99, v211, v212
  v_dot2_f32_bf16 v213, v103, v211, v213
  v_dot2_f32_bf16 v214, v107, v211, v214
  v_dot2_f32_bf16 v215, v111, v211, v215
  v_dot2_f32_bf16 v216, v115, v211, v216
  v_dot2_f32_bf16 v217, v119, v211, v217
  v_dot2_f32_bf16 v218, v123, v211, v218
  v_dot2_f32_bf16 v219, v127, v211, v219
  s_nop 4
  v_permlane32_swap_b32 v212, v216
  v_permlane32_swap_b32 v213, v217
  v_permlane32_swap_b32 v214, v218
  v_permlane32_swap_b32 v215, v219
  v_add_f32 v212, v212, v216
  v_add_f32 v213, v213, v217
  v_add_f32 v214, v214, v218
  v_add_f32 v215, v215, v219
  s_nop 1
  v_permlane16_swap_b32 v212, v214
  v_permlane16_swap_b32 v213, v215
  v_add_f32 v212, v212, v214
  v_add_f32 v213, v213, v215
  s_nop 1
  v_add_f32_dpp v212, v212, v212 row_ror:8 row_mask:0xf bank_mask:0xf
  v_add_f32_dpp v213, v213, v213 row_ror:8 row_mask:0xf bank_mask:0xf
  s_nop 1
  v_mov_b32_dpp v212, v213 quad_perm:[0,1,2,3] row_mask:0xf bank_mask:0xc
  s_nop 1
  v_add_f32_dpp v15, v212, v212 quad_perm:[1,0,3,2] row_mask:0xf bank_mask:0xf
  s_nop 1
  v_add_f32_dpp v15, v15, v15 quad_perm:[2,3,0,1] row_mask:0xf bank_mask:0xf
  s_nop 1
  v_add_f32_dpp v15, v15, v15 row_half_mirror row_mask:0xf bank_mask:0xf
  v_cvt_pk_bf16_f32 v15, v15, v15
  v_and_b32 v15, 0xffff0000, v15
  v_mul_f32 v15, 0xbfb8aa3b, v15
  v_exp_f32 v15, v15
  s_nop 0
  v_add_f32 v15, 1.0, v15
  v_rcp_f32 v15, v15
  s_nop 0
  v_cvt_pk_bf16_f32 v15, v15, v15
  v_and_b32 v236, 0xffff0000, v15
  v_sub_f32 v15, 1.0, v236
  v_cvt_pk_bf16_f32 v15, v15, v15
  v_and_b32 v237, 0xffff0000, v15
  s_waitcnt lgkmcnt(0)
  s_barrier
  v_lshrrev_b32 v15, 3, v0
  s_lshl_b32 s73, s60, 3
  v_add_u32 v15, s73, v15
  v_lshlrev_b32 v15, 2, v15
  ds_write_b32 v15, v236 offset:4096
  ds_write_b32 v15, v237 offset:4352
  ds_read_b64_tr_b16 v[80:81], v246 offset:8192
  ds_read_b64_tr_b16 v[82:83], v246 offset:9216
  ds_read_b64_tr_b16 v[84:85], v247 offset:8192
  ds_read_b64_tr_b16 v[86:87], v247 offset:9216
  ds_read_b64_tr_b16 v[88:89], v246 offset:10240
  ds_read_b64_tr_b16 v[90:91], v246 offset:11264
  ds_read_b64_tr_b16 v[92:93], v247 offset:10240
  ds_read_b64_tr_b16 v[94:95], v247 offset:11264
  ds_read_b64_tr_b16 v[96:97], v246 offset:20480
  ds_read_b64_tr_b16 v[98:99], v246 offset:21504
  ds_read_b64_tr_b16 v[100:101], v247 offset:20480
  ds_read_b64_tr_b16 v[102:103], v247 offset:21504
  ds_read_b64_tr_b16 v[104:105], v246 offset:22528
  ds_read_b64_tr_b16 v[106:107], v246 offset:23552
  ds_read_b64_tr_b16 v[108:109], v247 offset:22528
  ds_read_b64_tr_b16 v[110:111], v247 offset:23552
  ds_read_b64_tr_b16 v[112:113], v246 offset:0
  ds_read_b64_tr_b16 v[114:115], v246 offset:1024
  ds_read_b64_tr_b16 v[116:117], v247 offset:0
  ds_read_b64_tr_b16 v[118:119], v247 offset:1024
  ds_read_b64_tr_b16 v[120:121], v246 offset:2048
  ds_read_b64_tr_b16 v[122:123], v246 offset:3072
  ds_read_b64_tr_b16 v[124:125], v247 offset:2048
  ds_read_b64_tr_b16 v[126:127], v247 offset:3072
  ds_read_b64_tr_b16 v[128:129], v246 offset:12288
  ds_read_b64_tr_b16 v[130:131], v246 offset:13312
  ds_read_b64_tr_b16 v[132:133], v247 offset:12288
  ds_read_b64_tr_b16 v[134:135], v247 offset:13312
  ds_read_b64_tr_b16 v[136:137], v246 offset:14336
  ds_read_b64_tr_b16 v[138:139], v246 offset:15360
  ds_read_b64_tr_b16 v[140:141], v247 offset:14336
  ds_read_b64_tr_b16 v[142:143], v247 offset:15360
  s_mov_b32 s80, 0
L_OF_LOOPL:
  s_waitcnt vmcnt(0)
  v_cmp_ne_u32 vcc, s69, v14
  s_add_u32 s80, s80, 1
  s_cbranch_vccz L_OF_OKL
  s_cmp_gt_u32 s80, 20000
  s_cbranch_scc1 L_OF_OKL
  buffer_load_dword v14, v13, s[24:27], s72 offen sc1
  s_branch L_OF_LOOPL
L_OF_OKL:
  buffer_load_dwordx4 v[144:147], v12, s[24:27], s71 offen offset:0 sc1
  buffer_load_dwordx4 v[148:151], v12, s[24:27], s71 offen offset:1024 sc1
  buffer_load_dwordx4 v[152:155], v12, s[24:27], s71 offen offset:2048 sc1
  buffer_load_dwordx4 v[156:159], v12, s[24:27], s71 offen offset:3072 sc1
  s_add_u32 s71, s71, 4096
  buffer_load_dwordx4 v[160:163], v12, s[24:27], s71 offen offset:0 sc1
  buffer_load_dwordx4 v[164:167], v12, s[24:27], s71 offen offset:1024 sc1
  buffer_load_dwordx4 v[168:171], v12, s[24:27], s71 offen offset:2048 sc1
  buffer_load_dwordx4 v[172:175], v12, s[24:27], s71 offen offset:3072 sc1
  s_add_u32 s71, s71, 4096
  buffer_load_dwordx4 v[176:179], v12, s[24:27], s71 offen offset:0 sc1
  buffer_load_dwordx4 v[180:183], v12, s[24:27], s71 offen offset:1024 sc1
  buffer_load_dwordx4 v[184:187], v12, s[24:27], s71 offen offset:2048 sc1
  buffer_load_dwordx4 v[188:191], v12, s[24:27], s71 offen offset:3072 sc1
  s_add_u32 s71, s71, 4096
  buffer_load_dwordx4 v[192:195], v12, s[24:27], s71 offen offset:0 sc1
  buffer_load_dwordx4 v[196:199], v12, s[24:27], s71 offen offset:1024 sc1
  buffer_load_dwordx4 v[200:203], v12, s[24:27], s71 offen offset:2048 sc1
  buffer_load_dwordx4 v[204:207], v12, s[24:27], s71 offen offset:3072 sc1
L_P3_J:
  s_lshl_b32 s73, s44, 15
  s_lshl_b32 s74, s45, 11
  s_add_u32 s74, s74, s73
  s_add_u32 s74, s74, 98304
  v_and_b32 v4, 31, v0
  v_lshrrev_b32 v5, 5, v0
  v_lshlrev_b32 v5, 9, v5
  v_add_u32 v5, s74, v5
  v_mov_b32 v6, v4
  v_and_b32 v6, 31, v6
  v_lshl_add_u32 v8, v6, 4, v5
  v_add_u32 v6, 4, v4
  v_and_b32 v6, 31, v6
  v_lshl_add_u32 v9, v6, 4, v5
  v_add_u32 v6, 8, v4
  v_and_b32 v6, 31, v6
  v_lshl_add_u32 v10, v6, 4, v5
  v_add_u32 v6, 12, v4
  v_and_b32 v6, 31, v6
  v_lshl_add_u32 v11, v6, 4, v5
  v_lshrrev_b32 v4, 3, v0
  s_lshl_b32 s74, s45, 3
  v_add_u32 v4, s74, v4
  v_and_b32 v5, 7, v0
  v_and_b32 v6, 3, v5
  v_lshl_add_u32 v6, v6, 2, v4
  v_and_b32 v6, 31, v6
  v_lshlrev_b32 v6, 4, v6
  v_lshrrev_b32 v7, 1, v5
  v_lshl_add_u32 v6, v7, 13, v6
  v_and_b32 v7, 1, v5
  v_lshl_add_u32 v6, v7, 10, v6
  s_add_u32 s73, s73, 98304
  v_add_u32 v2, s73, v6
  s_mov_b32 s80, 0
L_P3_RETRY:
  v_mov_b32 v15, 0
  s_waitcnt vmcnt(15)
  v_mfma_f32_32x32x16_bf16 v[208:223], v[16:19], v[144:147], 0
  v_max3_u32 v15, v15, v144, v145
  v_mfma_f32_32x32x16_bf16 v[224:239], v[20:23], v[144:147], 0
  v_max3_u32 v15, v15, v146, v147
  s_waitcnt vmcnt(14)
  v_mfma_f32_32x32x16_bf16 v[208:223], v[24:27], v[148:151], v[208:223]
  v_max3_u32 v15, v15, v148, v149
  v_mfma_f32_32x32x16_bf16 v[224:239], v[28:31], v[148:151], v[224:239]
  v_max3_u32 v15, v15, v150, v151
  s_waitcnt vmcnt(13)
  v_mfma_f32_32x32x16_bf16 v[208:223], v[32:35], v[152:155], v[208:223]
  v_max3_u32 v15, v15, v152, v153
  v_mfma_f32_32x32x16_bf16 v[224:239], v[36:39], v[152:155], v[224:239]
  v_max3_u32 v15, v15, v154, v155
  s_waitcnt vmcnt(12)
  v_mfma_f32_32x32x16_bf16 v[208:223], v[40:43], v[156:159], v[208:223]
  v_max3_u32 v15, v15, v156, v157
  v_mfma_f32_32x32x16_bf16 v[224:239], v[44:47], v[156:159], v[224:239]
  v_max3_u32 v15, v15, v158, v159
  s_waitcnt vmcnt(11)
  v_mfma_f32_32x32x16_bf16 v[208:223], v[48:51], v[160:163], v[208:223]
  v_max3_u32 v15, v15, v160, v161
  v_mfma_f32_32x32x16_bf16 v[224:239], v[52:55], v[160:163], v[224:239]
  v_max3_u32 v15, v15, v162, v163
  s_waitcnt vmcnt(10)
  v_mfma_f32_32x32x16_bf16 v[208:223], v[56:59], v[164:167], v[208:223]
  v_max3_u32 v15, v15, v164, v165
  v_mfma_f32_32x32x16_bf16 v[224:239], v[60:63], v[164:167], v[224:239]
  v_max3_u32 v15, v15, v166, v167
  s_waitcnt vmcnt(9)
  v_mfma_f32_32x32x16_bf16 v[208:223], v[64:67], v[168:171], v[208:223]
  v_max3_u32 v15, v15, v168, v169
  v_mfma_f32_32x32x16_bf16 v[224:239], v[68:71], v[168:171], v[224:239]
  v_max3_u32 v15, v15, v170, v171
  s_waitcnt vmcnt(8)
  v_mfma_f32_32x32x16_bf16 v[208:223], v[72:75], v[172:175], v[208:223]
  v_max3_u32 v15, v15, v172, v173
  v_mfma_f32_32x32x16_bf16 v[224:239], v[76:79], v[172:175], v[224:239]
  v_max3_u32 v15, v15, v174, v175
  s_waitcnt lgkmcnt(0)
  s_waitcnt vmcnt(7)
  v_mfma_f32_32x32x16_bf16 v[208:223], v[80:83], v[176:179], v[208:223]
  v_max3_u32 v15, v15, v176, v177
  v_mfma_f32_32x32x16_bf16 v[224:239], v[84:87], v[176:179], v[224:239]
  v_max3_u32 v15, v15, v178, v179
  s_waitcnt vmcnt(6)
  v_mfma_f32_32x32x16_bf16 v[208:223], v[88:91], v[180:183], v[208:223]
  v_max3_u32 v15, v15, v180, v181
  v_mfma_f32_32x32x16_bf16 v[224:239], v[92:95], v[180:183], v[224:239]
  v_max3_u32 v15, v15, v182, v183
  s_waitcnt vmcnt(5)
  v_mfma_f32_32x32x16_bf16 v[208:223], v[96:99], v[184:187], v[208:223]
  v_max3_u32 v15, v15, v184, v185
  v_mfma_f32_32x32x16_bf16 v[224:239], v[100:103], v[184:187], v[224:239]
  v_max3_u32 v15, v15, v186, v187
  s_waitcnt vmcnt(4)
  v_mfma_f32_32x32x16_bf16 v[208:223], v[104:107], v[188:191], v[208:223]
  v_max3_u32 v15, v15, v188, v189
  v_mfma_f32_32x32x16_bf16 v[224:239], v[108:111], v[188:191], v[224:239]
  v_max3_u32 v15, v15, v190, v191
  s_waitcnt vmcnt(3)
  v_mfma_f32_32x32x16_bf16 v[208:223], v[112:115], v[192:195], v[208:223]
  v_max3_u32 v15, v15, v192, v193
  v_mfma_f32_32x32x16_bf16 v[224:239], v[116:119], v[192:195], v[224:239]
  v_max3_u32 v15, v15, v194, v195
  s_waitcnt vmcnt(2)
  v_mfma_f32_32x32x16_bf16 v[208:223], v[120:123], v[196:199], v[208:223]
  v_max3_u32 v15, v15, v196, v197
  v_mfma_f32_32x32x16_bf16 v[224:239], v[124:127], v[196:199], v[224:239]
  v_max3_u32 v15, v15, v198, v199
  s_waitcnt vmcnt(1)
  v_mfma_f32_32x32x16_bf16 v[208:223], v[128:131], v[200:203], v[208:223]
  v_max3_u32 v15, v15, v200, v201
  v_mfma_f32_32x32x16_bf16 v[224:239], v[132:135], v[200:203], v[224:239]
  v_max3_u32 v15, v15, v202, v203
  s_waitcnt vmcnt(0)
  v_mfma_f32_32x32x16_bf16 v[208:223], v[136:139], v[204:207], v[208:223]
  v_max3_u32 v15, v15, v204, v205
  v_mfma_f32_32x32x16_bf16 v[224:239], v[140:143], v[204:207], v[224:239]
  v_max3_u32 v15, v15, v206, v207
  v_cmp_eq_u32 vcc, -1, v15
  s_add_u32 s80, s80, 1
  s_cbranch_vccz L_P3_DONE
  s_cmp_gt_u32 s80, 20000
  s_cbranch_scc1 L_P3_DONE
  s_sub_u32 s71, s71, 12288
  s_nop 7
  buffer_load_dwordx4 v[144:147], v12, s[24:27], s71 offen offset:0 sc1
  buffer_load_dwordx4 v[148:151], v12, s[24:27], s71 offen offset:1024 sc1
  buffer_load_dwordx4 v[152:155], v12, s[24:27], s71 offen offset:2048 sc1
  buffer_load_dwordx4 v[156:159], v12, s[24:27], s71 offen offset:3072 sc1
  s_add_u32 s71, s71, 4096
  buffer_load_dwordx4 v[160:163], v12, s[24:27], s71 offen offset:0 sc1
  buffer_load_dwordx4 v[164:167], v12, s[24:27], s71 offen offset:1024 sc1
  buffer_load_dwordx4 v[168:171], v12, s[24:27], s71 offen offset:2048 sc1
  buffer_load_dwordx4 v[172:175], v12, s[24:27], s71 offen offset:3072 sc1
  s_add_u32 s71, s71, 4096
  buffer_load_dwordx4 v[176:179], v12, s[24:27], s71 offen offset:0 sc1
  buffer_load_dwordx4 v[180:183], v12, s[24:27], s71 offen offset:1024 sc1
  buffer_load_dwordx4 v[184:187], v12, s[24:27], s71 offen offset:2048 sc1
  buffer_load_dwordx4 v[188:191], v12, s[24:27], s71 offen offset:3072 sc1
  s_add_u32 s71, s71, 4096
  buffer_load_dwordx4 v[192:195], v12, s[24:27], s71 offen offset:0 sc1
  buffer_load_dwordx4 v[196:199], v12, s[24:27], s71 offen offset:1024 sc1
  buffer_load_dwordx4 v[200:203], v12, s[24:27], s71 offen offset:2048 sc1
  buffer_load_dwordx4 v[204:207], v12, s[24:27], s71 offen offset:3072 sc1
  s_branch L_P3_RETRY
L_P3_DONE:
  s_lshl_b32 s73, s44, 5
  v_add_u32 v3, s73, v4
  v_lshlrev_b32 v3, 2, v3
  v_lshlrev_b32 v4, 10, v4
  v_lshl_add_u32 v4, v5, 4, v4
  s_lshl_b32 s73, s50, 15
  s_lshl_b32 s74, s68, 7
  s_add_u32 s73, s73, s74
  s_nop 1
  ds_write_b128 v8, v[208:211] offset:0
  ds_write_b128 v9, v[212:215] offset:1024
  ds_write_b128 v10, v[216:219] offset:8192
  ds_write_b128 v11, v[220:223] offset:9216
  ds_write_b128 v8, v[224:227] offset:16384
  ds_write_b128 v9, v[228:231] offset:17408
  ds_write_b128 v10, v[232:235] offset:24576
  ds_write_b128 v11, v[236:239] offset:25600
  s_waitcnt lgkmcnt(0)
  s_barrier
  ds_read_b32 v5, v3 offset:4096
  ds_read_b32 v6, v3 offset:4352
  ds_read_b128 v[144:147], v2 offset:0
  ds_read_b128 v[148:151], v2 offset:512
  ds_read_b128 v[152:155], v2 offset:2048
  ds_read_b128 v[156:159], v2 offset:2560
  ds_read_b128 v[160:163], v2 offset:4096
  ds_read_b128 v[164:167], v2 offset:4608
  ds_read_b128 v[168:171], v2 offset:6144
  ds_read_b128 v[172:175], v2 offset:6656
  s_waitcnt lgkmcnt(4)
  v_add_f32 v144, v144, v152
  v_add_f32 v145, v145, v153
  v_add_f32 v146, v146, v154
  v_add_f32 v147, v147, v155
  v_add_f32 v148, v148, v156
  v_add_f32 v149, v149, v157
  v_add_f32 v150, v150, v158
  v_add_f32 v151, v151, v159
  v_mul_f32 v144, v144, v5
  v_mul_f32 v145, v145, v5
  v_mul_f32 v146, v146, v5
  v_mul_f32 v147, v147, v5
  v_mul_f32 v148, v148, v5
  v_mul_f32 v149, v149, v5
  v_mul_f32 v150, v150, v5
  v_mul_f32 v151, v151, v5
  s_waitcnt lgkmcnt(0)
  v_add_f32 v160, v160, v168
  v_add_f32 v161, v161, v169
  v_add_f32 v162, v162, v170
  v_add_f32 v163, v163, v171
  v_add_f32 v164, v164, v172
  v_add_f32 v165, v165, v173
  v_add_f32 v166, v166, v174
  v_add_f32 v167, v167, v175
  v_fmac_f32 v144, v160, v6
  v_fmac_f32 v145, v161, v6
  v_fmac_f32 v146, v162, v6
  v_fmac_f32 v147, v163, v6
  v_fmac_f32 v148, v164, v6
  v_fmac_f32 v149, v165, v6
  v_fmac_f32 v150, v166, v6
  v_fmac_f32 v151, v167, v6
  v_cvt_pk_bf16_f32 v176, v144, v145
  v_cvt_pk_bf16_f32 v177, v146, v147
  v_cvt_pk_bf16_f32 v178, v148, v149
  v_cvt_pk_bf16_f32 v179, v150, v151
  buffer_store_dwordx4 v[176:179], v4, s[28:31], s73 offen
  s_waitcnt vmcnt(0)
L_END:
  s_endpgm
L_ROLE_LO:
  s_mov_b32 s73, 0xff800000
  v_xor_b32 v144, s73, v16
  v_xor_b32 v145, s73, v17
  v_xor_b32 v146, s73, v18
  v_xor_b32 v147, s73, v19
  v_xor_b32 v148, s73, v20
  v_xor_b32 v149, s73, v21
  v_xor_b32 v150, s73, v22
  v_xor_b32 v151, s73, v23
  v_xor_b32 v152, s73, v24
  v_xor_b32 v153, s73, v25
  v_xor_b32 v154, s73, v26
  v_xor_b32 v155, s73, v27
  v_xor_b32 v156, s73, v28
  v_xor_b32 v157, s73, v29
  v_xor_b32 v158, s73, v30
  v_xor_b32 v159, s73, v31
  s_cmp_eq_u32 s62, 0
  s_cbranch_scc1 L_ROLE_C0
  s_cmp_gt_u32 s61, 1
  s_cbranch_scc1 L_ROLE_HI
  v_lshrrev_b32 v13, 3, v0
  v_lshlrev_b32 v13, 10, v13
  v_bfe_u32 v15, v0, 4, 1
  v_lshlrev_b32 v15, 2, v15
  v_xor_b32 v15, v15, v0
  v_and_b32 v15, 7, v15
  v_lshl_add_u32 v14, v15, 4, v13
  s_lshl_b32 s76, s68, 7
  s_and_b32 s71, s61, 1
  s_lshl_b32 s71, s71, 18
  s_add_u32 s71, s71, s76
  s_lshl_b32 s72, s61, 14
  s_add_u32 s72, s72, 98304
  s_cmp_ge_u32 s61, 2
  s_cbranch_scc1 L_WE_0_B
  s_mov_b32 s75, s71
  s_mov_b32 m0, s72
  s_nop 0
  buffer_load_dwordx4 v14, s[16:19], s75 offen lds
  s_add_u32 m0, m0, 1024
  s_add_u32 s75, s75, 8192
  buffer_load_dwordx4 v14, s[16:19], s75 offen lds
  s_add_u32 m0, m0, 1024
  s_add_u32 s75, s75, 8192
  buffer_load_dwordx4 v14, s[16:19], s75 offen lds
  s_add_u32 m0, m0, 1024
  s_add_u32 s75, s75, 8192
  buffer_load_dwordx4 v14, s[16:19], s75 offen lds
  s_add_u32 m0, m0, 1024
  s_add_u32 s75, s75, 8192
  buffer_load_dwordx4 v14, s[16:19], s75 offen lds
  s_add_u32 m0, m0, 1024
  s_add_u32 s75, s75, 8192
  buffer_load_dwordx4 v14, s[16:19], s75 offen lds
  s_add_u32 m0, m0, 1024
  s_add_u32 s75, s75, 8192
  buffer_load_dwordx4 v14, s[16:19], s75 offen lds
  s_add_u32 m0, m0, 1024
  s_add_u32 s75, s75, 8192
  buffer_load_dwordx4 v14, s[16:19], s75 offen lds
  s_add_u32 m0, m0, 1024
  s_add_u32 s75, s75, 8192
  buffer_load_dwordx4 v14, s[16:19], s75 offen lds
  s_add_u32 m0, m0, 1024
  s_add_u32 s75, s75, 8192
  buffer_load_dwordx4 v14, s[16:19], s75 offen lds
  s_add_u32 m0, m0, 1024
  s_add_u32 s75, s75, 8192
  buffer_load_dwordx4 v14, s[16:19], s75 offen lds
  s_add_u32 m0, m0, 1024
  s_add_u32 s75, s75, 8192
  buffer_load_dwordx4 v14, s[16:19], s75 offen lds
  s_add_u32 m0, m0, 1024
  s_add_u32 s75, s75, 8192
  buffer_load_dwordx4 v14, s[16:19], s75 offen lds
  s_add_u32 m0, m0, 1024
  s_add_u32 s75, s75, 8192
  buffer_load_dwordx4 v14, s[16:19], s75 offen lds
  s_add_u32 m0, m0, 1024
  s_add_u32 s75, s75, 8192
  buffer_load_dwordx4 v14, s[16:19], s75 offen lds
  s_add_u32 m0, m0, 1024
  s_add_u32 s75, s75, 8192
  buffer_load_dwordx4 v14, s[16:19], s75 offen lds
  s_branch L_WE_0_E
L_WE_0_B:
  s_mov_b32 s75, s71
  s_mov_b32 m0, s72
  s_nop 0
  buffer_load_dwordx4 v14, s[20:23], s75 offen lds
  s_add_u32 m0, m0, 1024
  s_add_u32 s75, s75, 8192
  buffer_load_dwordx4 v14, s[20:23], s75 offen lds
  s_add_u32 m0, m0, 1024
  s_add_u32 s75, s75, 8192
  buffer_load_dwordx4 v14, s[20:23], s75 offen lds
  s_add_u32 m0, m0, 1024
  s_add_u32 s75, s75, 8192
  buffer_load_dwordx4 v14, s[20:23], s75 offen lds
  s_add_u32 m0, m0, 1024
  s_add_u32 s75, s75, 8192
  buffer_load_dwordx4 v14, s[20:23], s75 offen lds
  s_add_u32 m0, m0, 1024
  s_add_u32 s75, s75, 8192
  buffer_load_dwordx4 v14, s[20:23], s75 offen lds
  s_add_u32 m0, m0, 1024
  s_add_u32 s75, s75, 8192
  buffer_load_dwordx4 v14, s[20:23], s75 offen lds
  s_add_u32 m0, m0, 1024
  s_add_u32 s75, s75, 8192
  buffer_load_dwordx4 v14, s[20:23], s75 offen lds
  s_add_u32 m0, m0, 1024
  s_add_u32 s75, s75, 8192
  buffer_load_dwordx4 v14, s[20:23], s75 offen lds
  s_add_u32 m0, m0, 1024
  s_add_u32 s75, s75, 8192
  buffer_load_dwordx4 v14, s[20:23], s75 offen lds
  s_add_u32 m0, m0, 1024
  s_add_u32 s75, s75, 8192
  buffer_load_dwordx4 v14, s[20:23], s75 offen lds
  s_add_u32 m0, m0, 1024
  s_add_u32 s75, s75, 8192
  buffer_load_dwordx4 v14, s[20:23], s75 offen lds
  s_add_u32 m0, m0, 1024
  s_add_u32 s75, s75, 8192
  buffer_load_dwordx4 v14, s[20:23], s75 offen lds
  s_add_u32 m0, m0, 1024
  s_add_u32 s75, s75, 8192
  buffer_load_dwordx4 v14, s[20:23], s75 offen lds
  s_add_u32 m0, m0, 1024
  s_add_u32 s75, s75, 8192
  buffer_load_dwordx4 v14, s[20:23], s75 offen lds
  s_add_u32 m0, m0, 1024
  s_add_u32 s75, s75, 8192
  buffer_load_dwordx4 v14, s[20:23], s75 offen lds
L_WE_0_E:
  s_sub_u32 s73, s62, 1
  s_lshl_b32 s74, s73, 5
  s_add_u32 s74, s74, s63
  s_lshl_b32 s74, s74, 7
  s_lshl_b32 s75, s61, 3
  s_add_u32 s74, s74, s75
  s_add_u32 s74, s74, 16384
  v_and_b32 v13, 1, v0
  v_lshlrev_b32 v13, 2, v13
  s_mov_b32 s80, 0
L_KVF_LOOP1:
  buffer_load_dword v15, v13, s[24:27], s74 offen sc1
  s_add_u32 s80, s80, 1
  s_waitcnt vmcnt(0)
  v_cmp_ne_u32 vcc, s69, v15
  s_cmp_gt_u32 s80, 20000
  s_cbranch_scc1 L_KVF_OK1
  s_cbranch_vccnz L_KVF_LOOP1
L_KVF_OK1:
  s_lshl_b32 s74, s63, 6
  s_lshl_b32 s73, s73, 3
  s_add_u32 s74, s74, s73
  s_lshl_b32 s73, s61, 1
  s_add_u32 s74, s74, s73
  s_lshl_b32 s74, s74, 12
  s_add_u32 s74, s74, 1048576
  buffer_load_dwordx4 v[64:67], v12, s[24:27], s74 offen offset:0 sc1
  buffer_load_dwordx4 v[68:71], v12, s[24:27], s74 offen offset:1024 sc1
  buffer_load_dwordx4 v[72:75], v12, s[24:27], s74 offen offset:2048 sc1
  buffer_load_dwordx4 v[76:79], v12, s[24:27], s74 offen offset:3072 sc1
  s_add_u32 s74, s74, 4096
  buffer_load_dwordx4 v[80:83], v12, s[24:27], s74 offen offset:0 sc1
  buffer_load_dwordx4 v[84:87], v12, s[24:27], s74 offen offset:1024 sc1
  buffer_load_dwordx4 v[88:91], v12, s[24:27], s74 offen offset:2048 sc1
  buffer_load_dwordx4 v[92:95], v12, s[24:27], s74 offen offset:3072 sc1
  s_lshl_b32 s73, s50, 15
  s_lshl_b32 s74, s45, 13
  s_add_u32 s73, s73, s74
  buffer_load_dwordx4 v[208:211], v12, s[32:35], 0 offen
  buffer_load_dwordx4 v[96:99], v12, s[8:11], s73 offen offset:0
  buffer_load_dwordx4 v[100:103], v12, s[8:11], s73 offen offset:1024
  buffer_load_dwordx4 v[104:107], v12, s[8:11], s73 offen offset:2048
  buffer_load_dwordx4 v[108:111], v12, s[8:11], s73 offen offset:3072
  s_add_u32 s73, s73, 4096
  buffer_load_dwordx4 v[112:115], v12, s[8:11], s73 offen offset:0
  buffer_load_dwordx4 v[116:119], v12, s[8:11], s73 offen offset:1024
  buffer_load_dwordx4 v[120:123], v12, s[8:11], s73 offen offset:2048
  buffer_load_dwordx4 v[124:127], v12, s[8:11], s73 offen offset:3072
  s_mul_i32 s73, s61, 24576
  s_add_u32 s73, s73, 4096
  v_add_u32 v13, s73, v12
  s_waitcnt vmcnt(13)
  ds_write_b128 v13, v[64:67] offset:0
  ds_write_b128 v13, v[68:71] offset:1024
  ds_write_b128 v13, v[72:75] offset:2048
  ds_write_b128 v13, v[76:79] offset:3072
  s_waitcnt vmcnt(9)
  ds_write_b128 v13, v[80:83] offset:12288
  ds_write_b128 v13, v[84:87] offset:13312
  ds_write_b128 v13, v[88:91] offset:14336
  ds_write_b128 v13, v[92:95] offset:15360
  s_waitcnt lgkmcnt(0)
  s_branch L_HALO_BAR
L_ROLE_HI:
  s_sub_u32 s73, s62, 1
  s_lshl_b32 s74, s73, 5
  s_add_u32 s74, s74, s63
  s_lshl_b32 s74, s74, 7
  s_lshl_b32 s75, s61, 3
  s_add_u32 s74, s74, s75
  s_add_u32 s74, s74, 16384
  v_and_b32 v13, 1, v0
  v_lshlrev_b32 v13, 2, v13
  s_mov_b32 s80, 0
L_KVF_LOOP2:
  buffer_load_dword v15, v13, s[24:27], s74 offen sc1
  s_add_u32 s80, s80, 1
  s_waitcnt vmcnt(0)
  v_cmp_ne_u32 vcc, s69, v15
  s_cmp_gt_u32 s80, 20000
  s_cbranch_scc1 L_KVF_OK2
  s_cbranch_vccnz L_KVF_LOOP2
L_KVF_OK2:
  s_lshl_b32 s74, s63, 6
  s_lshl_b32 s73, s73, 3
  s_add_u32 s74, s74, s73
  s_lshl_b32 s73, s61, 1
  s_add_u32 s74, s74, s73
  s_lshl_b32 s74, s74, 12
  s_add_u32 s74, s74, 1048576
  buffer_load_dwordx4 v[64:67], v12, s[24:27], s74 offen offset:0 sc1
  buffer_load_dwordx4 v[68:71], v12, s[24:27], s74 offen offset:1024 sc1
  buffer_load_dwordx4 v[72:75], v12, s[24:27], s74 offen offset:2048 sc1
  buffer_load_dwordx4 v[76:79], v12, s[24:27], s74 offen offset:3072 sc1
  s_add_u32 s74, s74, 4096
  buffer_load_dwordx4 v[80:83], v12, s[24:27], s74 offen offset:0 sc1
  buffer_load_dwordx4 v[84:87], v12, s[24:27], s74 offen offset:1024 sc1
  buffer_load_dwordx4 v[88:91], v12, s[24:27], s74 offen offset:2048 sc1
  buffer_load_dwordx4 v[92:95], v12, s[24:27], s74 offen offset:3072 sc1
  v_lshrrev_b32 v13, 3, v0
  v_lshlrev_b32 v13, 10, v13
  v_bfe_u32 v15, v0, 4, 1
  v_lshlrev_b32 v15, 2, v15
  v_xor_b32 v15, v15, v0
  v_and_b32 v15, 7, v15
  v_lshl_add_u32 v14, v15, 4, v13
  s_lshl_b32 s76, s68, 7
  s_and_b32 s71, s61, 1
  s_lshl_b32 s71, s71, 18
  s_add_u32 s71, s71, s76
  s_lshl_b32 s72, s61, 14
  s_add_u32 s72, s72, 98304
  s_cmp_ge_u32 s61, 2
  s_cbranch_scc1 L_WE_3_B
  s_mov_b32 s75, s71
  s_mov_b32 m0, s72
  s_nop 0
  buffer_load_dwordx4 v14, s[16:19], s75 offen lds
  s_add_u32 m0, m0, 1024
  s_add_u32 s75, s75, 8192
  buffer_load_dwordx4 v14, s[16:19], s75 offen lds
  s_add_u32 m0, m0, 1024
  s_add_u32 s75, s75, 8192
  buffer_load_dwordx4 v14, s[16:19], s75 offen lds
  s_add_u32 m0, m0, 1024
  s_add_u32 s75, s75, 8192
  buffer_load_dwordx4 v14, s[16:19], s75 offen lds
  s_add_u32 m0, m0, 1024
  s_add_u32 s75, s75, 8192
  buffer_load_dwordx4 v14, s[16:19], s75 offen lds
  s_add_u32 m0, m0, 1024
  s_add_u32 s75, s75, 8192
  buffer_load_dwordx4 v14, s[16:19], s75 offen lds
  s_add_u32 m0, m0, 1024
  s_add_u32 s75, s75, 8192
  buffer_load_dwordx4 v14, s[16:19], s75 offen lds
  s_add_u32 m0, m0, 1024
  s_add_u32 s75, s75, 8192
  buffer_load_dwordx4 v14, s[16:19], s75 offen lds
  s_add_u32 m0, m0, 1024
  s_add_u32 s75, s75, 8192
  buffer_load_dwordx4 v14, s[16:19], s75 offen lds
  s_add_u32 m0, m0, 1024
  s_add_u32 s75, s75, 8192
  buffer_load_dwordx4 v14, s[16:19], s75 offen lds
  s_add_u32 m0, m0, 1024
  s_add_u32 s75, s75, 8192
  buffer_load_dwordx4 v14, s[16:19], s75 offen lds
  s_add_u32 m0, m0, 1024
  s_add_u32 s75, s75, 8192
  buffer_load_dwordx4 v14, s[16:19], s75 offen lds
  s_add_u32 m0, m0, 1024
  s_add_u32 s75, s75, 8192
  buffer_load_dwordx4 v14, s[16:19], s75 offen lds
  s_add_u32 m0, m0, 1024
  s_add_u32 s75, s75, 8192
  buffer_load_dwordx4 v14, s[16:19], s75 offen lds
  s_add_u32 m0, m0, 1024
  s_add_u32 s75, s75, 8192
  buffer_load_dwordx4 v14, s[16:19], s75 offen lds
  s_add_u32 m0, m0, 1024
  s_add_u32 s75, s75, 8192
  buffer_load_dwordx4 v14, s[16:19], s75 offen lds
  s_branch L_WE_3_E
L_WE_3_B:
  s_mov_b32 s75, s71
  s_mov_b32 m0, s72
  s_nop 0
  buffer_load_dwordx4 v14, s[20:23], s75 offen lds
  s_add_u32 m0, m0, 1024
  s_add_u32 s75, s75, 8192
  buffer_load_dwordx4 v14, s[20:23], s75 offen lds
  s_add_u32 m0, m0, 1024
  s_add_u32 s75, s75, 8192
  buffer_load_dwordx4 v14, s[20:23], s75 offen lds
  s_add_u32 m0, m0, 1024
  s_add_u32 s75, s75, 8192
  buffer_load_dwordx4 v14, s[20:23], s75 offen lds
  s_add_u32 m0, m0, 1024
  s_add_u32 s75, s75, 8192
  buffer_load_dwordx4 v14, s[20:23], s75 offen lds
  s_add_u32 m0, m0, 1024
  s_add_u32 s75, s75, 8192
  buffer_load_dwordx4 v14, s[20:23], s75 offen lds
  s_add_u32 m0, m0, 1024
  s_add_u32 s75, s75, 8192
  buffer_load_dwordx4 v14, s[20:23], s75 offen lds
  s_add_u32 m0, m0, 1024
  s_add_u32 s75, s75, 8192
  buffer_load_dwordx4 v14, s[20:23], s75 offen lds
  s_add_u32 m0, m0, 1024
  s_add_u32 s75, s75, 8192
  buffer_load_dwordx4 v14, s[20:23], s75 offen lds
  s_add_u32 m0, m0, 1024
  s_add_u32 s75, s75, 8192
  buffer_load_dwordx4 v14, s[20:23], s75 offen lds
  s_add_u32 m0, m0, 1024
  s_add_u32 s75, s75, 8192
  buffer_load_dwordx4 v14, s[20:23], s75 offen lds
  s_add_u32 m0, m0, 1024
  s_add_u32 s75, s75, 8192
  buffer_load_dwordx4 v14, s[20:23], s75 offen lds
  s_add_u32 m0, m0, 1024
  s_add_u32 s75, s75, 8192
  buffer_load_dwordx4 v14, s[20:23], s75 offen lds
  s_add_u32 m0, m0, 1024
  s_add_u32 s75, s75, 8192
  buffer_load_dwordx4 v14, s[20:23], s75 offen lds
  s_add_u32 m0, m0, 1024
  s_add_u32 s75, s75, 8192
  buffer_load_dwordx4 v14, s[20:23], s75 offen lds
  s_add_u32 m0, m0, 1024
  s_add_u32 s75, s75, 8192
  buffer_load_dwordx4 v14, s[20:23], s75 offen lds
L_WE_3_E:
  s_lshl_b32 s73, s50, 15
  s_lshl_b32 s74, s45, 13
  s_add_u32 s73, s73, s74
  buffer_load_dwordx4 v[208:211], v12, s[32:35], 0 offen
  buffer_load_dwordx4 v[96:99], v12, s[8:11], s73 offen offset:0
  buffer_load_dwordx4 v[100:103], v12, s[8:11], s73 offen offset:1024
  buffer_load_dwordx4 v[104:107], v12, s[8:11], s73 offen offset:2048
  buffer_load_dwordx4 v[108:111], v12, s[8:11], s73 offen offset:3072
  s_add_u32 s73, s73, 4096
  buffer_load_dwordx4 v[112:115], v12, s[8:11], s73 offen offset:0
  buffer_load_dwordx4 v[116:119], v12, s[8:11], s73 offen offset:1024
  buffer_load_dwordx4 v[120:123], v12, s[8:11], s73 offen offset:2048
  buffer_load_dwordx4 v[124:127], v12, s[8:11], s73 offen offset:3072
  s_mul_i32 s73, s61, 24576
  s_add_u32 s73, s73, 4096
  v_add_u32 v13, s73, v12
  s_waitcnt vmcnt(29)
  ds_write_b128 v13, v[64:67] offset:0
  ds_write_b128 v13, v[68:71] offset:1024
  ds_write_b128 v13, v[72:75] offset:2048
  ds_write_b128 v13, v[76:79] offset:3072
  s_waitcnt vmcnt(25)
  ds_write_b128 v13, v[80:83] offset:12288
  ds_write_b128 v13, v[84:87] offset:13312
  ds_write_b128 v13, v[88:91] offset:14336
  ds_write_b128 v13, v[92:95] offset:15360
  s_waitcnt vmcnt(9) lgkmcnt(0)
  s_branch L_HALO_BAR
L_ROLE_C0:
  v_lshrrev_b32 v13, 3, v0
  v_lshlrev_b32 v13, 10, v13
  v_bfe_u32 v15, v0, 4, 1
  v_lshlrev_b32 v15, 2, v15
  v_xor_b32 v15, v15, v0
  v_and_b32 v15, 7, v15
  v_lshl_add_u32 v14, v15, 4, v13
  s_lshl_b32 s76, s68, 7
  s_and_b32 s71, s61, 1
  s_lshl_b32 s71, s71, 18
  s_add_u32 s71, s71, s76
  s_lshl_b32 s72, s61, 14
  s_add_u32 s72, s72, 98304
  s_cmp_ge_u32 s61, 2
  s_cbranch_scc1 L_WE_4_B
  s_mov_b32 s75, s71
  s_mov_b32 m0, s72
  s_nop 0
  buffer_load_dwordx4 v14, s[16:19], s75 offen lds
  s_add_u32 m0, m0, 1024
  s_add_u32 s75, s75, 8192
  buffer_load_dwordx4 v14, s[16:19], s75 offen lds
  s_add_u32 m0, m0, 1024
  s_add_u32 s75, s75, 8192
  buffer_load_dwordx4 v14, s[16:19], s75 offen lds
  s_add_u32 m0, m0, 1024
  s_add_u32 s75, s75, 8192
  buffer_load_dwordx4 v14, s[16:19], s75 offen lds
  s_add_u32 m0, m0, 1024
  s_add_u32 s75, s75, 8192
  buffer_load_dwordx4 v14, s[16:19], s75 offen lds
  s_add_u32 m0, m0, 1024
  s_add_u32 s75, s75, 8192
  buffer_load_dwordx4 v14, s[16:19], s75 offen lds
  s_add_u32 m0, m0, 1024
  s_add_u32 s75, s75, 8192
  buffer_load_dwordx4 v14, s[16:19], s75 offen lds
  s_add_u32 m0, m0, 1024
  s_add_u32 s75, s75, 8192
  buffer_load_dwordx4 v14, s[16:19], s75 offen lds
  s_add_u32 m0, m0, 1024
  s_add_u32 s75, s75, 8192
  buffer_load_dwordx4 v14, s[16:19], s75 offen lds
  s_add_u32 m0, m0, 1024
  s_add_u32 s75, s75, 8192
  buffer_load_dwordx4 v14, s[16:19], s75 offen lds
  s_add_u32 m0, m0, 1024
  s_add_u32 s75, s75, 8192
  buffer_load_dwordx4 v14, s[16:19], s75 offen lds
  s_add_u32 m0, m0, 1024
  s_add_u32 s75, s75, 8192
  buffer_load_dwordx4 v14, s[16:19], s75 offen lds
  s_add_u32 m0, m0, 1024
  s_add_u32 s75, s75, 8192
  buffer_load_dwordx4 v14, s[16:19], s75 offen lds
  s_add_u32 m0, m0, 1024
  s_add_u32 s75, s75, 8192
  buffer_load_dwordx4 v14, s[16:19], s75 offen lds
  s_add_u32 m0, m0, 1024
  s_add_u32 s75, s75, 8192
  buffer_load_dwordx4 v14, s[16:19], s75 offen lds
  s_add_u32 m0, m0, 1024
  s_add_u32 s75, s75, 8192
  buffer_load_dwordx4 v14, s[16:19], s75 offen lds
  s_branch L_WE_4_E
L_WE_4_B:
  s_mov_b32 s75, s71
  s_mov_b32 m0, s72
  s_nop 0
  buffer_load_dwordx4 v14, s[20:23], s75 offen lds
  s_add_u32 m0, m0, 1024
  s_add_u32 s75, s75, 8192
  buffer_load_dwordx4 v14, s[20:23], s75 offen lds
  s_add_u32 m0, m0, 1024
  s_add_u32 s75, s75, 8192
  buffer_load_dwordx4 v14, s[20:23], s75 offen lds
  s_add_u32 m0, m0, 1024
  s_add_u32 s75, s75, 8192
  buffer_load_dwordx4 v14, s[20:23], s75 offen lds
  s_add_u32 m0, m0, 1024
  s_add_u32 s75, s75, 8192
  buffer_load_dwordx4 v14, s[20:23], s75 offen lds
  s_add_u32 m0, m0, 1024
  s_add_u32 s75, s75, 8192
  buffer_load_dwordx4 v14, s[20:23], s75 offen lds
  s_add_u32 m0, m0, 1024
  s_add_u32 s75, s75, 8192
  buffer_load_dwordx4 v14, s[20:23], s75 offen lds
  s_add_u32 m0, m0, 1024
  s_add_u32 s75, s75, 8192
  buffer_load_dwordx4 v14, s[20:23], s75 offen lds
  s_add_u32 m0, m0, 1024
  s_add_u32 s75, s75, 8192
  buffer_load_dwordx4 v14, s[20:23], s75 offen lds
  s_add_u32 m0, m0, 1024
  s_add_u32 s75, s75, 8192
  buffer_load_dwordx4 v14, s[20:23], s75 offen lds
  s_add_u32 m0, m0, 1024
  s_add_u32 s75, s75, 8192
  buffer_load_dwordx4 v14, s[20:23], s75 offen lds
  s_add_u32 m0, m0, 1024
  s_add_u32 s75, s75, 8192
  buffer_load_dwordx4 v14, s[20:23], s75 offen lds
  s_add_u32 m0, m0, 1024
  s_add_u32 s75, s75, 8192
  buffer_load_dwordx4 v14, s[20:23], s75 offen lds
  s_add_u32 m0, m0, 1024
  s_add_u32 s75, s75, 8192
  buffer_load_dwordx4 v14, s[20:23], s75 offen lds
  s_add_u32 m0, m0, 1024
  s_add_u32 s75, s75, 8192
  buffer_load_dwordx4 v14, s[20:23], s75 offen lds
  s_add_u32 m0, m0, 1024
  s_add_u32 s75, s75, 8192
  buffer_load_dwordx4 v14, s[20:23], s75 offen lds
L_WE_4_E:
  s_lshl_b32 s73, s50, 15
  s_lshl_b32 s74, s45, 13
  s_add_u32 s73, s73, s74
  buffer_load_dwordx4 v[208:211], v12, s[32:35], 0 offen
  buffer_load_dwordx4 v[96:99], v12, s[8:11], s73 offen offset:0
  buffer_load_dwordx4 v[100:103], v12, s[8:11], s73 offen offset:1024
  buffer_load_dwordx4 v[104:107], v12, s[8:11], s73 offen offset:2048
  buffer_load_dwordx4 v[108:111], v12, s[8:11], s73 offen offset:3072
  s_add_u32 s73, s73, 4096
  buffer_load_dwordx4 v[112:115], v12, s[8:11], s73 offen offset:0
  buffer_load_dwordx4 v[116:119], v12, s[8:11], s73 offen offset:1024
  buffer_load_dwordx4 v[120:123], v12, s[8:11], s73 offen offset:2048
  buffer_load_dwordx4 v[124:127], v12, s[8:11], s73 offen offset:3072
  s_waitcnt vmcnt(9)
  s_branch L_HALO_BAR
L_LATE_S:
  s_cmp_eq_u32 s60, 4
  s_cbranch_scc0 L_FW_E
  s_lshl_b32 s73, s62, 5
  s_lshr_b32 s74, s63, 3
  s_add_u32 s73, s73, s74
  s_lshl_b32 s73, s73, 7
  s_add_u32 s73, s73, 65536
  v_lshlrev_b32 v13, 9, v0
  v_add_u32 v13, s73, v13
  s_mov_b64 exec, 0xff
  buffer_load_dword v215, v13, s[24:27], 0 offen sc1
  s_mov_b64 exec, -1
  s_lshr_b32 s73, s67, 2
  s_lshl_b32 s73, s73, 3
  s_and_b32 s74, s67, 3
  s_add_u32 s71, s73, s74
  s_sub_u32 s74, 7, s74
  s_add_u32 s72, s73, s74
  s_lshl_b32 s71, s71, 9
  s_lshl_b32 s72, s72, 9
  s_add_u32 s71, s71, 65536
  s_add_u32 s72, s72, 65536
  v_lshlrev_b32 v13, 7, v0
  s_mov_b64 exec, 15
  buffer_load_dword v215, v13, s[24:27], s71 offen sc1
  buffer_load_dword v214, v13, s[24:27], s72 offen sc1
  s_mov_b64 exec, -1
L_FW_E:
  v_lshrrev_b32 v13, 3, v0
  v_lshlrev_b32 v13, 10, v13
  v_bfe_u32 v15, v0, 4, 1
  v_lshlrev_b32 v15, 2, v15
  v_xor_b32 v15, v15, v0
  v_and_b32 v15, 7, v15
  v_lshl_add_u32 v14, v15, 4, v13
  s_sub_u32 s73, 7, s61
  s_lshl_b32 s76, s68, 7
  s_and_b32 s71, s73, 1
  s_lshl_b32 s71, s71, 18
  s_add_u32 s71, s71, s76
  s_add_u32 s71, s71, 131072
  s_mul_i32 s72, s73, 24576
  s_cmp_ge_u32 s73, 2
  s_cbranch_scc1 L_LATE_B
  s_add_u32 s74, s72, 8192
  s_mov_b32 m0, s74
  s_nop 0
  buffer_load_dwordx4 v14, s[16:19], s71 offen lds
  s_add_u32 m0, m0, 1024
  s_add_u32 s71, s71, 8192
  buffer_load_dwordx4 v14, s[16:19], s71 offen lds
  s_add_u32 m0, m0, 1024
  s_add_u32 s71, s71, 8192
  buffer_load_dwordx4 v14, s[16:19], s71 offen lds
  s_add_u32 m0, m0, 1024
  s_add_u32 s71, s71, 8192
  buffer_load_dwordx4 v14, s[16:19], s71 offen lds
  s_add_u32 s71, s71, 8192
  s_add_u32 s74, s72, 20480
  s_mov_b32 m0, s74
  s_nop 0
  buffer_load_dwordx4 v14, s[16:19], s71 offen lds
  s_add_u32 m0, m0, 1024
  s_add_u32 s71, s71, 8192
  buffer_load_dwordx4 v14, s[16:19], s71 offen lds
  s_add_u32 m0, m0, 1024
  s_add_u32 s71, s71, 8192
  buffer_load_dwordx4 v14, s[16:19], s71 offen lds
  s_add_u32 m0, m0, 1024
  s_add_u32 s71, s71, 8192
  buffer_load_dwordx4 v14, s[16:19], s71 offen lds
  s_add_u32 s71, s71, 8192
  s_add_u32 s74, s72, 0
  s_mov_b32 m0, s74
  s_nop 0
  buffer_load_dwordx4 v14, s[16:19], s71 offen lds
  s_add_u32 m0, m0, 1024
  s_add_u32 s71, s71, 8192
  buffer_load_dwordx4 v14, s[16:19], s71 offen lds
  s_add_u32 m0, m0, 1024
  s_add_u32 s71, s71, 8192
  buffer_load_dwordx4 v14, s[16:19], s71 offen lds
  s_add_u32 m0, m0, 1024
  s_add_u32 s71, s71, 8192
  buffer_load_dwordx4 v14, s[16:19], s71 offen lds
  s_add_u32 s71, s71, 8192
  s_add_u32 s74, s72, 12288
  s_mov_b32 m0, s74
  s_nop 0
  buffer_load_dwordx4 v14, s[16:19], s71 offen lds
  s_add_u32 m0, m0, 1024
  s_add_u32 s71, s71, 8192
  buffer_load_dwordx4 v14, s[16:19], s71 offen lds
  s_add_u32 m0, m0, 1024
  s_add_u32 s71, s71, 8192
  buffer_load_dwordx4 v14, s[16:19], s71 offen lds
  s_add_u32 m0, m0, 1024
  s_add_u32 s71, s71, 8192
  buffer_load_dwordx4 v14, s[16:19], s71 offen lds
  s_add_u32 s71, s71, 8192
  s_branch L_LATE_G
L_LATE_B:
  s_add_u32 s74, s72, 8192
  s_mov_b32 m0, s74
  s_nop 0
  buffer_load_dwordx4 v14, s[20:23], s71 offen lds
  s_add_u32 m0, m0, 1024
  s_add_u32 s71, s71, 8192
  buffer_load_dwordx4 v14, s[20:23], s71 offen lds
  s_add_u32 m0, m0, 1024
  s_add_u32 s71, s71, 8192
  buffer_load_dwordx4 v14, s[20:23], s71 offen lds
  s_add_u32 m0, m0, 1024
  s_add_u32 s71, s71, 8192
  buffer_load_dwordx4 v14, s[20:23], s71 offen lds
  s_add_u32 s71, s71, 8192
  s_add_u32 s74, s72, 20480
  s_mov_b32 m0, s74
  s_nop 0
  buffer_load_dwordx4 v14, s[20:23], s71 offen lds
  s_add_u32 m0, m0, 1024
  s_add_u32 s71, s71, 8192
  buffer_load_dwordx4 v14, s[20:23], s71 offen lds
  s_add_u32 m0, m0, 1024
  s_add_u32 s71, s71, 8192
  buffer_load_dwordx4 v14, s[20:23], s71 offen lds
  s_add_u32 m0, m0, 1024
  s_add_u32 s71, s71, 8192
  buffer_load_dwordx4 v14, s[20:23], s71 offen lds
  s_add_u32 s71, s71, 8192
  s_add_u32 s74, s72, 0
  s_mov_b32 m0, s74
  s_nop 0
  buffer_load_dwordx4 v14, s[20:23], s71 offen lds
  s_add_u32 m0, m0, 1024
  s_add_u32 s71, s71, 8192
  buffer_load_dwordx4 v14, s[20:23], s71 offen lds
  s_add_u32 m0, m0, 1024
  s_add_u32 s71, s71, 8192
  buffer_load_dwordx4 v14, s[20:23], s71 offen lds
  s_add_u32 m0, m0, 1024
  s_add_u32 s71, s71, 8192
  buffer_load_dwordx4 v14, s[20:23], s71 offen lds
  s_add_u32 s71, s71, 8192
  s_add_u32 s74, s72, 12288
  s_mov_b32 m0, s74
  s_nop 0
  buffer_load_dwordx4 v14, s[20:23], s71 offen lds
  s_add_u32 m0, m0, 1024
  s_add_u32 s71, s71, 8192
  buffer_load_dwordx4 v14, s[20:23], s71 offen lds
  s_add_u32 m0, m0, 1024
  s_add_u32 s71, s71, 8192
  buffer_load_dwordx4 v14, s[20:23], s71 offen lds
  s_add_u32 m0, m0, 1024
  s_add_u32 s71, s71, 8192
  buffer_load_dwordx4 v14, s[20:23], s71 offen lds
  s_add_u32 s71, s71, 8192
L_LATE_G:
  s_lshl_b32 s73, s50, 15
  s_lshl_b32 s74, s45, 13
  s_add_u32 s73, s73, s74
  buffer_load_dwordx4 v[208:211], v12, s[32:35], 0 offen
  buffer_load_dwordx4 v[96:99], v12, s[8:11], s73 offen offset:0
  buffer_load_dwordx4 v[100:103], v12, s[8:11], s73 offen offset:1024
  buffer_load_dwordx4 v[104:107], v12, s[8:11], s73 offen offset:2048
  buffer_load_dwordx4 v[108:111], v12, s[8:11], s73 offen offset:3072
  s_add_u32 s73, s73, 4096
  buffer_load_dwordx4 v[112:115], v12, s[8:11], s73 offen offset:0
  buffer_load_dwordx4 v[116:119], v12, s[8:11], s73 offen offset:1024
  buffer_load_dwordx4 v[120:123], v12, s[8:11], s73 offen offset:2048
  buffer_load_dwordx4 v[124:127], v12, s[8:11], s73 offen offset:3072
  s_setprio 1
  s_branch L_LATE_E
L_P3_EARLY:
  v_lshlrev_b32 v13, 7, v0
  v_mov_b32 v14, s69
  s_waitcnt vmcnt(0)
  s_mov_b64 exec, 1
  buffer_store_dword v14, v13, s[24:27], s51 offen sc1
  s_mov_b64 exec, -1
  s_setprio 0
  v_mov_b32 v212, 0
  v_mov_b32 v213, 0
  v_mov_b32 v214, 0
  v_mov_b32 v215, 0
  v_mov_b32 v216, 0
  v_mov_b32 v217, 0
  v_mov_b32 v218, 0
  v_mov_b32 v219, 0
  v_dot2_f32_bf16 v212, v96, v208, v212
  v_dot2_f32_bf16 v213, v100, v208, v213
  v_dot2_f32_bf16 v214, v104, v208, v214
  v_dot2_f32_bf16 v215, v108, v208, v215
  v_dot2_f32_bf16 v216, v112, v208, v216
  v_dot2_f32_bf16 v217, v116, v208, v217
  v_dot2_f32_bf16 v218, v120, v208, v218
  v_dot2_f32_bf16 v219, v124, v208, v219
  v_dot2_f32_bf16 v212, v97, v209, v212
  v_dot2_f32_bf16 v213, v101, v209, v213
  v_dot2_f32_bf16 v214, v105, v209, v214
  v_dot2_f32_bf16 v215, v109, v209, v215
  v_dot2_f32_bf16 v216, v113, v209, v216
  v_dot2_f32_bf16 v217, v117, v209, v217
  v_dot2_f32_bf16 v218, v121, v209, v218
  v_dot2_f32_bf16 v219, v125, v209, v219
  v_dot2_f32_bf16 v212, v98, v210, v212
  v_dot2_f32_bf16 v213, v102, v210, v213
  v_dot2_f32_bf16 v214, v106, v210, v214
  v_dot2_f32_bf16 v215, v110, v210, v215
  v_dot2_f32_bf16 v216, v114, v210, v216
  v_dot2_f32_bf16 v217, v118, v210, v217
  v_dot2_f32_bf16 v218, v122, v210, v218
  v_dot2_f32_bf16 v219, v126, v210, v219
  v_dot2_f32_bf16 v212, v99, v211, v212
  v_dot2_f32_bf16 v213, v103, v211, v213
  v_dot2_f32_bf16 v214, v107, v211, v214
  v_dot2_f32_bf16 v215, v111, v211, v215
  v_dot2_f32_bf16 v216, v115, v211, v216
  v_dot2_f32_bf16 v217, v119, v211, v217
  v_dot2_f32_bf16 v218, v123, v211, v218
  v_dot2_f32_bf16 v219, v127, v211, v219
  s_nop 4
  v_permlane32_swap_b32 v212, v216
  v_permlane32_swap_b32 v213, v217
  v_permlane32_swap_b32 v214, v218
  v_permlane32_swap_b32 v215, v219
  v_add_f32 v212, v212, v216
  v_add_f32 v213, v213, v217
  v_add_f32 v214, v214, v218
  v_add_f32 v215, v215, v219
  s_nop 1
  v_permlane16_swap_b32 v212, v214
  v_permlane16_swap_b32 v213, v215
  v_add_f32 v212, v212, v214
  v_add_f32 v213, v213, v215
  s_nop 1
  v_add_f32_dpp v212, v212, v212 row_ror:8 row_mask:0xf bank_mask:0xf
  v_add_f32_dpp v213, v213, v213 row_ror:8 row_mask:0xf bank_mask:0xf
  s_nop 1
  v_mov_b32_dpp v212, v213 quad_perm:[0,1,2,3] row_mask:0xf bank_mask:0xc
  s_nop 1
  v_add_f32_dpp v15, v212, v212 quad_perm:[1,0,3,2] row_mask:0xf bank_mask:0xf
  s_nop 1
  v_add_f32_dpp v15, v15, v15 quad_perm:[2,3,0,1] row_mask:0xf bank_mask:0xf
  s_nop 1
  v_add_f32_dpp v15, v15, v15 row_half_mirror row_mask:0xf bank_mask:0xf
  v_cvt_pk_bf16_f32 v15, v15, v15
  v_and_b32 v15, 0xffff0000, v15
  v_mul_f32 v15, 0xbfb8aa3b, v15
  v_exp_f32 v15, v15
  s_nop 0
  v_add_f32 v15, 1.0, v15
  v_rcp_f32 v15, v15
  s_nop 0
  v_cvt_pk_bf16_f32 v15, v15, v15
  v_and_b32 v236, 0xffff0000, v15
  v_sub_f32 v15, 1.0, v236
  v_cvt_pk_bf16_f32 v15, v15, v15
  v_and_b32 v237, 0xffff0000, v15
  v_and_b32 v13, 7, v0
  v_lshlrev_b32 v13, 2, v13
  buffer_load_dword v14, v13, s[24:27], s72 offen sc1
  s_waitcnt lgkmcnt(0)
  s_barrier
  s_mov_b32 s80, 0
L_OF_LOOPE:
  s_waitcnt vmcnt(0)
  v_cmp_ne_u32 vcc, s69, v14
  s_add_u32 s80, s80, 1
  s_cbranch_vccz L_OF_OKE
  s_cmp_gt_u32 s80, 20000
  s_cbranch_scc1 L_OF_OKE
  buffer_load_dword v14, v13, s[24:27], s72 offen sc1
  s_branch L_OF_LOOPE
L_OF_OKE:
  buffer_load_dwordx4 v[144:147], v12, s[24:27], s71 offen offset:0 sc1
  buffer_load_dwordx4 v[148:151], v12, s[24:27], s71 offen offset:1024 sc1
  buffer_load_dwordx4 v[152:155], v12, s[24:27], s71 offen offset:2048 sc1
  buffer_load_dwordx4 v[156:159], v12, s[24:27], s71 offen offset:3072 sc1
  s_add_u32 s71, s71, 4096
  buffer_load_dwordx4 v[160:163], v12, s[24:27], s71 offen offset:0 sc1
  buffer_load_dwordx4 v[164:167], v12, s[24:27], s71 offen offset:1024 sc1
  buffer_load_dwordx4 v[168:171], v12, s[24:27], s71 offen offset:2048 sc1
  buffer_load_dwordx4 v[172:175], v12, s[24:27], s71 offen offset:3072 sc1
  s_add_u32 s71, s71, 4096
  buffer_load_dwordx4 v[176:179], v12, s[24:27], s71 offen offset:0 sc1
  buffer_load_dwordx4 v[180:183], v12, s[24:27], s71 offen offset:1024 sc1
  buffer_load_dwordx4 v[184:187], v12, s[24:27], s71 offen offset:2048 sc1
  buffer_load_dwordx4 v[188:191], v12, s[24:27], s71 offen offset:3072 sc1
  s_add_u32 s71, s71, 4096
  buffer_load_dwordx4 v[192:195], v12, s[24:27], s71 offen offset:0 sc1
  buffer_load_dwordx4 v[196:199], v12, s[24:27], s71 offen offset:1024 sc1
  buffer_load_dwordx4 v[200:203], v12, s[24:27], s71 offen offset:2048 sc1
  buffer_load_dwordx4 v[204:207], v12, s[24:27], s71 offen offset:3072 sc1
  v_lshrrev_b32 v15, 3, v0
  s_lshl_b32 s73, s60, 3
  v_add_u32 v15, s73, v15
  v_lshlrev_b32 v15, 2, v15
  ds_write_b32 v15, v236 offset:4096
  ds_write_b32 v15, v237 offset:4352
  ds_read_b64_tr_b16 v[80:81], v246 offset:8192
  ds_read_b64_tr_b16 v[82:83], v246 offset:9216
  ds_read_b64_tr_b16 v[84:85], v247 offset:8192
  ds_read_b64_tr_b16 v[86:87], v247 offset:9216
  ds_read_b64_tr_b16 v[88:89], v246 offset:10240
  ds_read_b64_tr_b16 v[90:91], v246 offset:11264
  ds_read_b64_tr_b16 v[92:93], v247 offset:10240
  ds_read_b64_tr_b16 v[94:95], v247 offset:11264
  ds_read_b64_tr_b16 v[96:97], v246 offset:20480
  ds_read_b64_tr_b16 v[98:99], v246 offset:21504
  ds_read_b64_tr_b16 v[100:101], v247 offset:20480
  ds_read_b64_tr_b16 v[102:103], v247 offset:21504
  ds_read_b64_tr_b16 v[104:105], v246 offset:22528
  ds_read_b64_tr_b16 v[106:107], v246 offset:23552
  ds_read_b64_tr_b16 v[108:109], v247 offset:22528
  ds_read_b64_tr_b16 v[110:111], v247 offset:23552
  ds_read_b64_tr_b16 v[112:113], v246 offset:0
  ds_read_b64_tr_b16 v[114:115], v246 offset:1024
  ds_read_b64_tr_b16 v[116:117], v247 offset:0
  ds_read_b64_tr_b16 v[118:119], v247 offset:1024
  ds_read_b64_tr_b16 v[120:121], v246 offset:2048
  ds_read_b64_tr_b16 v[122:123], v246 offset:3072
  ds_read_b64_tr_b16 v[124:125], v247 offset:2048
  ds_read_b64_tr_b16 v[126:127], v247 offset:3072
  ds_read_b64_tr_b16 v[128:129], v246 offset:12288
  ds_read_b64_tr_b16 v[130:131], v246 offset:13312
  ds_read_b64_tr_b16 v[132:133], v247 offset:12288
  ds_read_b64_tr_b16 v[134:135], v247 offset:13312
  ds_read_b64_tr_b16 v[136:137], v246 offset:14336
  ds_read_b64_tr_b16 v[138:139], v246 offset:15360
  ds_read_b64_tr_b16 v[140:141], v247 offset:14336
  ds_read_b64_tr_b16 v[142:143], v247 offset:15360
  s_branch L_P3_J
L_FB_ENTRY:
  s_lshl_b32 s73, s62, 5
  s_add_u32 s73, s73, s63
  s_lshl_b32 s73, s73, 7
  s_add_u32 s73, s73, 16384
  v_and_b32 v13, 7, v0
  v_lshlrev_b32 v13, 2, v13
  s_mov_b32 s80, 0
L_FB_FLAG:
  buffer_load_dword v14, v13, s[24:27], s73 offen sc1
  s_add_u32 s80, s80, 1
  s_waitcnt vmcnt(0)
  v_cmp_ne_u32 vcc, s69, v14
  s_cmp_gt_u32 s80, 20000
  s_cbranch_scc1 L_FB_FLAG_OK
  s_cbranch_vccnz L_FB_FLAG
L_FB_FLAG_OK:
  s_mov_b32 s83, 0
L_FB_H:
  s_lshr_b32 s73, s81, s83
  s_and_b32 s73, s73, 1
  s_cmp_eq_u32 s73, 0
  s_cbranch_scc1 L_FB_NEXT
  s_cmp_eq_u32 s83, 0
  s_cbranch_scc0 L_FB_Q1
  v_mov_b32 v64, v248
  v_mov_b32 v65, v249
  v_mov_b32 v66, v250
  v_mov_b32 v67, v251
  s_branch L_FB_Q2
L_FB_Q1:
  v_mov_b32 v64, v252
  v_mov_b32 v65, v253
  v_mov_b32 v66, v254
  v_mov_b32 v67, v255
L_FB_Q2:
  v_mov_b32 v68, 0xff800000
  v_mov_b32 v144, 0
  v_mov_b32 v145, 0
  v_mov_b32 v146, 0
  v_mov_b32 v147, 0
  v_mov_b32 v148, 0
  v_mov_b32 v149, 0
  v_mov_b32 v150, 0
  v_mov_b32 v151, 0
  v_mov_b32 v152, 0
  v_mov_b32 v153, 0
  v_mov_b32 v154, 0
  v_mov_b32 v155, 0
  v_mov_b32 v156, 0
  v_mov_b32 v157, 0
  v_mov_b32 v158, 0
  v_mov_b32 v159, 0
  v_mov_b32 v192, 0x3f803f80
  v_mov_b32 v193, 0x3f803f80
  v_mov_b32 v194, 0x3f803f80
  v_mov_b32 v195, 0x3f803f80
  v_mov_b32 v196, 0x3f803f80
  v_mov_b32 v197, 0x3f803f80
  v_mov_b32 v198, 0x3f803f80
  v_mov_b32 v199, 0x3f803f80
  s_mov_b32 s40, 0
L_FB_PASS:
  s_mov_b32 s41, 0
L_FB_PART:
  s_cmp_eq_u32 s41, 0
  s_cselect_b32 s42, 0, s61
  s_cselect_b32 s43, s61, 7
L_FB_TILE:
  s_cmp_eq_u32 s42, s61
  s_cbranch_scc1 L_FB_MASK
  v_mov_b32 v176, 0
  v_mov_b32 v177, 0
  v_mov_b32 v178, 0
  v_mov_b32 v179, 0
  v_mov_b32 v180, 0
  v_mov_b32 v181, 0
  v_mov_b32 v182, 0
  v_mov_b32 v183, 0
  v_mov_b32 v184, 0
  v_mov_b32 v185, 0
  v_mov_b32 v186, 0
  v_mov_b32 v187, 0
  v_mov_b32 v188, 0
  v_mov_b32 v189, 0
  v_mov_b32 v190, 0
  v_mov_b32 v191, 0
  s_branch L_FB_C
L_FB_MASK:
  v_and_b32 v13, 31, v0
  v_lshrrev_b32 v14, 5, v0
  v_lshlrev_b32 v14, 2, v14
  v_sub_u32 v13, v13, v14
  s_cmp_eq_u32 s41, 0
  s_cselect_b32 s73, 0, 0xff800000
  v_subrev_u32 v176, 0, v13
  v_ashrrev_i32 v176, 31, v176
  v_and_b32 v176, 0xff800000, v176
  v_xor_b32 v176, s73, v176
  v_subrev_u32 v177, 1, v13
  v_ashrrev_i32 v177, 31, v177
  v_and_b32 v177, 0xff800000, v177
  v_xor_b32 v177, s73, v177
  v_subrev_u32 v178, 2, v13
  v_ashrrev_i32 v178, 31, v178
  v_and_b32 v178, 0xff800000, v178
  v_xor_b32 v178, s73, v178
  v_subrev_u32 v179, 3, v13
  v_ashrrev_i32 v179, 31, v179
  v_and_b32 v179, 0xff800000, v179
  v_xor_b32 v179, s73, v179
  v_subrev_u32 v180, 8, v13
  v_ashrrev_i32 v180, 31, v180
  v_and_b32 v180, 0xff800000, v180
  v_xor_b32 v180, s73, v180
  v_subrev_u32 v181, 9, v13
  v_ashrrev_i32 v181, 31, v181
  v_and_b32 v181, 0xff800000, v181
  v_xor_b32 v181, s73, v181
  v_subrev_u32 v182, 10, v13
  v_ashrrev_i32 v182, 31, v182
  v_and_b32 v182, 0xff800000, v182
  v_xor_b32 v182, s73, v182
  v_subrev_u32 v183, 11, v13
  v_ashrrev_i32 v183, 31, v183
  v_and_b32 v183, 0xff800000, v183
  v_xor_b32 v183, s73, v183
  v_subrev_u32 v184, 16, v13
  v_ashrrev_i32 v184, 31, v184
  v_and_b32 v184, 0xff800000, v184
  v_xor_b32 v184, s73, v184
  v_subrev_u32 v185, 17, v13
  v_ashrrev_i32 v185, 31, v185
  v_and_b32 v185, 0xff800000, v185
  v_xor_b32 v185, s73, v185
  v_subrev_u32 v186, 18, v13
  v_ashrrev_i32 v186, 31, v186
  v_and_b32 v186, 0xff800000, v186
  v_xor_b32 v186, s73, v186
  v_subrev_u32 v187, 19, v13
  v_ashrrev_i32 v187, 31, v187
  v_and_b32 v187, 0xff800000, v187
  v_xor_b32 v187, s73, v187
  v_subrev_u32 v188, 24, v13
  v_ashrrev_i32 v188, 31, v188
  v_and_b32 v188, 0xff800000, v188
  v_xor_b32 v188, s73, v188
  v_subrev_u32 v189, 25, v13
  v_ashrrev_i32 v189, 31, v189
  v_and_b32 v189, 0xff800000, v189
  v_xor_b32 v189, s73, v189
  v_subrev_u32 v190, 26, v13
  v_ashrrev_i32 v190, 31, v190
  v_and_b32 v190, 0xff800000, v190
  v_xor_b32 v190, s73, v190
  v_subrev_u32 v191, 27, v13
  v_ashrrev_i32 v191, 31, v191
  v_and_b32 v191, 0xff800000, v191
  v_xor_b32 v191, s73, v191
L_FB_C:
  s_sub_u32 s73, s62, s41
  s_lshl_b32 s73, s73, 3
  s_add_u32 s73, s73, s42
  s_lshl_b32 s74, s63, 6
  s_add_u32 s73, s73, s74
  s_lshl_b32 s73, s73, 12
  s_add_u32 s73, s73, 1048576
  s_lshl_b32 s74, s83, 10
  s_add_u32 s74, s74, s73
  buffer_load_dwordx4 v[56:59], v12, s[24:27], s74 offen sc1
  s_lshl_b32 s74, s83, 8
  s_add_u32 s74, s74, s73
  s_mov_b64 exec, s[78:79]
  buffer_load_dwordx4 v[192:195], v12, s[24:27], s74 offen offset:2048 sc1
  buffer_load_dwordx4 v[196:199], v12, s[24:27], s74 offen offset:3072 sc1
  s_mov_b64 exec, -1
  s_waitcnt vmcnt(0)
  v_mfma_f32_32x32x16_bf16 v[160:175], v[56:59], v[64:67], v[176:191]
  s_nop 7
  s_nop 7
  s_cmp_eq_u32 s40, 0
  s_cbranch_scc0 L_FB_P2
  v_max3_f32 v68, v68, v160, v161
  v_max3_f32 v68, v68, v162, v163
  v_max3_f32 v68, v68, v164, v165
  v_max3_f32 v68, v68, v166, v167
  v_max3_f32 v68, v68, v168, v169
  v_max3_f32 v68, v68, v170, v171
  v_max3_f32 v68, v68, v172, v173
  v_max3_f32 v68, v68, v174, v175
  s_branch L_FB_TNEXT
L_FB_P2:
  v_sub_f32 v160, v160, v68
  v_sub_f32 v161, v161, v68
  v_sub_f32 v162, v162, v68
  v_sub_f32 v163, v163, v68
  v_sub_f32 v164, v164, v68
  v_sub_f32 v165, v165, v68
  v_sub_f32 v166, v166, v68
  v_sub_f32 v167, v167, v68
  v_sub_f32 v168, v168, v68
  v_sub_f32 v169, v169, v68
  v_sub_f32 v170, v170, v68
  v_sub_f32 v171, v171, v68
  v_sub_f32 v172, v172, v68
  v_sub_f32 v173, v173, v68
  v_sub_f32 v174, v174, v68
  v_sub_f32 v175, v175, v68
  v_exp_f32 v160, v160
  v_exp_f32 v161, v161
  v_exp_f32 v162, v162
  v_exp_f32 v163, v163
  v_exp_f32 v164, v164
  v_exp_f32 v165, v165
  v_exp_f32 v166, v166
  v_exp_f32 v167, v167
  v_exp_f32 v168, v168
  v_exp_f32 v169, v169
  v_exp_f32 v170, v170
  v_exp_f32 v171, v171
  v_exp_f32 v172, v172
  v_exp_f32 v173, v173
  v_exp_f32 v174, v174
  v_exp_f32 v175, v175
  s_nop 0
  v_cvt_pk_bf16_f32 v48, v160, v161
  v_cvt_pk_bf16_f32 v49, v162, v163
  v_cvt_pk_bf16_f32 v50, v164, v165
  v_cvt_pk_bf16_f32 v51, v166, v167
  v_cvt_pk_bf16_f32 v52, v168, v169
  v_cvt_pk_bf16_f32 v53, v170, v171
  v_cvt_pk_bf16_f32 v54, v172, v173
  v_cvt_pk_bf16_f32 v55, v174, v175
  s_nop 1
  v_mfma_f32_32x32x16_bf16 v[144:159], v[192:195], v[48:51], v[144:159]
  v_mfma_f32_32x32x16_bf16 v[144:159], v[196:199], v[52:55], v[144:159]
  s_nop 7
  s_nop 7
L_FB_TNEXT:
  s_add_u32 s42, s42, 1
  s_cmp_le_u32 s42, s43
  s_cbranch_scc1 L_FB_TILE
  s_cmp_eq_u32 s62, 0
  s_cbranch_scc1 L_FB_PDONE
  s_add_u32 s41, s41, 1
  s_cmp_lt_u32 s41, 2
  s_cbranch_scc1 L_FB_PART
L_FB_PDONE:
  s_cmp_eq_u32 s40, 0
  s_cbranch_scc0 L_FB_STORE
  v_mov_b32 v69, v68
  s_nop 1
  v_permlane32_swap_b32 v68, v69
  s_nop 1
  v_max_f32 v68, v68, v69
  s_mov_b32 s40, 1
  s_branch L_FB_PASS
L_FB_STORE:
  s_cmp_eq_u32 s83, 0
  s_cbranch_scc0 L_FB_S1
  v_mov_b32 v216, v144
  v_mov_b32 v217, v145
  v_mov_b32 v218, v146
  v_mov_b32 v219, v147
  v_mov_b32 v220, v148
  v_mov_b32 v221, v149
  v_mov_b32 v222, v150
  v_mov_b32 v223, v151
  v_mov_b32 v224, v152
  v_mov_b32 v225, v153
  v_mov_b32 v226, v154
  v_mov_b32 v227, v155
  v_mov_b32 v228, v156
  v_mov_b32 v229, v157
  v_mov_b32 v230, v158
  v_mov_b32 v231, v159
  s_branch L_FB_NEXT
L_FB_S1:
  v_mov_b32 v232, v144
  v_mov_b32 v233, v145
  v_mov_b32 v234, v146
  v_mov_b32 v235, v147
  v_mov_b32 v236, v148
  v_mov_b32 v237, v149
  v_mov_b32 v238, v150
  v_mov_b32 v239, v151
  v_mov_b32 v240, v152
  v_mov_b32 v241, v153
  v_mov_b32 v242, v154
  v_mov_b32 v243, v155
  v_mov_b32 v244, v156
  v_mov_b32 v245, v157
  v_mov_b32 v246, v158
  v_mov_b32 v247, v159
L_FB_NEXT:
  s_add_u32 s83, s83, 1
  s_cmp_lt_u32 s83, 2
  s_cbranch_scc1 L_FB_H
  s_branch L_NOFB
L_CODE_END:
.section .rodata,"a"
.p2align 6
.amdhsa_kernel gated_mix__sliding_block__sliding_block__prompt_kernel
  .amdhsa_next_free_vgpr 256
  .amdhsa_next_free_sgpr 102
  .amdhsa_accum_offset 256
  .amdhsa_group_segment_fixed_size 0
  .amdhsa_kernarg_size 80
  .amdhsa_user_sgpr_count 2
  .amdhsa_user_sgpr_kernarg_segment_ptr 1
  .amdhsa_system_sgpr_workgroup_id_x 1
  .amdhsa_float_denorm_mode_32 3
.end_amdhsa_kernel
```
